```python
import torch

def _softmax(x, axis=-1):
    return torch.softmax(x, dim=axis)
def _gelu(x):
    return torch.nn.functional.gelu(x, approximate="tanh")
def _silu(x):
    return torch.nn.functional.silu(x)
def _sigmoid(x):
    return torch.sigmoid(x)
def _layernorm(x, axis=-1, eps=1e-5):
    m = x.mean(dim=axis, keepdim=True)
    v = x.var(dim=axis, keepdim=True, unbiased=False)
    return (x - m) / torch.sqrt(v + eps)
def _scatter_add(tgt, idx, src, axis=0):
    return tgt.clone().index_add_(axis, idx, src)
def _segment_sum(src, seg, n):
    out = torch.zeros((n,) + src.shape[1:], dtype=src.dtype)
    return out.index_add_(0, seg, src)
def _pad(x, pw):
    flat = tuple(v for pair in reversed(pw) for v in pair)
    return torch.nn.functional.pad(x, flat)

kernel_name = 'recurrent_scan__gqa_block_cached__swiglu_ffn__decode'

def setup_inputs():

    _w = (lambda a: (lambda t: t.to(torch.bfloat16) if t.is_floating_point() else t)(torch.as_tensor(a)))
    def _A_setup():
        B, Sq, D = 1, 1, 576
        Hq, Hkv, Sk, Dh = 32, 16, 65536, 128
        assert Hq % Hkv == 0, (Hq, Hkv)
        return {
            "x": _w((lambda *s: torch.randn(*s, dtype=torch.bfloat16) * 0.05)(B, Sq, D)),
            "k_cache": _w((lambda *s: torch.randn(*s, dtype=torch.bfloat16) * 1.6)(B, Hkv, Sk, Dh)),
            "v_cache": _w((lambda *s: torch.randn(*s, dtype=torch.bfloat16) * 0.2)(B, Hkv, Sk, Dh)),
            "wq": _w((lambda *s: torch.randn(*s, dtype=torch.bfloat16) * 1.6)(D, Hq * Dh) * (D ** -0.5)),
            "wo": _w((lambda *s: torch.randn(*s, dtype=torch.bfloat16) * 0.2)(Hq * Dh, D) * ((Hq * Dh) ** -0.5)),
        }
    _A_in = _A_setup()

    def _B_setup():
        B, S, D, F = 1, 1, 576, 4608
        return {
            "x": _w((lambda *s: torch.randn(*s, dtype=torch.bfloat16) * 0.05)(B, S, D)),
            "w_gate": _w((lambda *s: torch.randn(*s, dtype=torch.bfloat16) * 0.1)(D, F)),
            "w_up": _w((lambda *s: torch.randn(*s, dtype=torch.bfloat16) * 0.1)(D, F)),
            "w_down": _w((lambda *s: torch.randn(*s, dtype=torch.bfloat16) * 0.1)(F, D)),
        }
    _B_in = _B_setup()

    return {
        "A_x": _A_in["x"],
        "A_k_cache": _A_in["k_cache"],
        "A_v_cache": _A_in["v_cache"],
        "A_wq": _A_in["wq"],
        "A_wo": _A_in["wo"],
        "B_x": _B_in["x"],
        "B_w_gate": _B_in["w_gate"],
        "B_w_up": _B_in["w_up"],
        "B_w_down": _B_in["w_down"],
    }

def reference(A_x, A_k_cache, A_v_cache, A_wq, A_wo, B_x, B_w_gate, B_w_up, B_w_down):
    def _A_ref(x, k_cache, v_cache, wq, wo):
        B, Sq, D = x.shape
        Hq, Dh = 32, 128
        Hkv = k_cache.shape[1]
        rep = Hq // Hkv
        q = (lambda x, *d: x.permute(*d))((x @ wq).reshape(B, Sq, Hq, Dh), 0, 2, 1, 3)
        k = (lambda x, n, axis: torch.repeat_interleave(x, n, dim=axis))(k_cache, rep, axis=1)
        v = (lambda x, n, axis: torch.repeat_interleave(x, n, dim=axis))(v_cache, rep, axis=1)
        scores = torch.einsum("bhqd,bhkd->bhqk", q, k) * (Dh ** -0.5)
        p = _softmax(scores, axis=-1)
        o = torch.einsum("bhqk,bhkd->bhqd", p, v)
        return (lambda x, *d: x.permute(*d))(o, 0, 2, 1, 3).reshape(B, Sq, Hq * Dh) @ wo

    def _B_ref(x, w_gate, w_up, w_down):
        g = _silu(x @ w_gate)
        u = x @ w_up
        return (g * u) @ w_down

    x = A_x
    xn = _layernorm(x, axis=-1)
    s = _A_ref(xn, A_k_cache, A_v_cache, A_wq, A_wo)
    g = _silu(_B_ref(xn, B_w_gate, B_w_up, B_w_down))
    return x + s * g
```

```asm
; @launch grid=(256,1,1) block=(256,1,1) lds=10752
.amdgcn_target "amdgcn-amd-amdhsa--gfx950"
.text
.globl recurrent_scan__gqa_block_cached__swiglu_ffn__decode_kernel
.p2align 8
.type recurrent_scan__gqa_block_cached__swiglu_ffn__decode_kernel,@function
recurrent_scan__gqa_block_cached__swiglu_ffn__decode_kernel:
    s_cmp_ge_u32 s2, 256
    s_cbranch_scc1 L_END
    s_load_dwordx16 s[8:23], s[0:1], 0
    s_load_dwordx8 s[24:31], s[0:1], 64
    v_and_b32 v1, 63, v0
    v_lshrrev_b32 v35, 6, v0
    s_nop 0
    v_readfirstlane_b32 s68, v35
    s_lshr_b32 s78, s2, 4
    s_and_b32 s79, s2, 15
    s_lshl_b32 s81, s79, 2
    s_add_u32 s81, s81, s68
    s_lshl_b32 s84, s79, 4
    s_add_u32 s84, s84, s78
    s_mov_b32 s75, 0x3fb8aa3b
    s_mov_b32 s76, 0x3db504f3
    s_lshl_b32 s82, s78, 8
    s_add_u32 s82, s82, 0x38000
    v_lshlrev_b32 v2, 4, v1
    v_mov_b32 v47, 0
    v_lshlrev_b32 v35, 1, v1
    v_lshrrev_b32 v46, 4, v0
    v_and_b32 v45, 15, v0
    v_lshlrev_b32 v45, 3, v45
    s_lshr_b32 s69, s79, 2
    s_mul_i32 s69, s69, 144
    v_add_u32 v44, s69, v46
    v_lshl_add_u32 v236, v44, 13, v45
    v_lshlrev_b32 v44, 1, v44
    s_and_b32 s69, s78, 3
    s_mul_i32 s69, s69, 144
    v_add_u32 v46, s69, v46
    v_mul_u32_u24 v237, 9216, v46
    v_add_u32 v237, v237, v45
    v_lshlrev_b32 v46, 1, v46
    s_lshl_b32 s72, s78, 9
    s_and_b32 s69, s79, 3
    s_lshl_b32 s69, s69, 7
    s_add_u32 s72, s72, s69
    s_and_b32 s73, s81, 7
    s_lshl_b32 s73, s73, 8
    s_lshr_b32 s71, s81, 3
    s_add_u32 s73, s73, s71
    s_lshl_b32 s73, s73, 13
    s_waitcnt lgkmcnt(0)
    s_mov_b32 s40, s8
    s_mov_b32 s41, s9
    s_mov_b32 s42, 0x480
    s_mov_b32 s43, 0x00020000
    s_mov_b32 s60, s14
    s_mov_b32 s61, s15
    s_mov_b32 s62, 0x480000
    s_mov_b32 s63, 0x00020000
    s_mul_i32 s69, s68, 1280
    s_add_u32 s69, s69, 256
    s_mov_b32 m0, s69
    s_nop 0
    buffer_load_dwordx4 v2, s[40:43], 0 offen lds
    s_mov_b64 exec, 0xff
    buffer_load_dwordx4 v2, s[40:43], 0 offen offset:1024 lds
    s_mov_b64 exec, -1
    buffer_load_dwordx2 v[112:113], v236, s[60:63], s72 offen nt
    s_add_u32 s72, s72, 131072
    buffer_load_dwordx2 v[114:115], v236, s[60:63], s72 offen nt
    s_add_u32 s72, s72, 131072
    buffer_load_dwordx2 v[116:117], v236, s[60:63], s72 offen nt
    s_add_u32 s72, s72, 131072
    buffer_load_dwordx2 v[118:119], v236, s[60:63], s72 offen nt
    s_add_u32 s72, s72, 131072
    buffer_load_dwordx2 v[120:121], v236, s[60:63], s72 offen nt
    s_add_u32 s72, s72, 131072
    buffer_load_dwordx2 v[122:123], v236, s[60:63], s72 offen nt
    s_add_u32 s72, s72, 131072
    buffer_load_dwordx2 v[124:125], v236, s[60:63], s72 offen nt
    s_add_u32 s72, s72, 131072
    buffer_load_dwordx2 v[126:127], v236, s[60:63], s72 offen nt
    s_add_u32 s72, s72, 131072
    buffer_load_dwordx2 v[128:129], v236, s[60:63], s72 offen nt
    v_add_u32 v35, s69, v35
    v_add_u32 v44, s69, v44
    v_add_u32 v46, s69, v46
    s_lshl_b32 s69, s78, 24
    s_add_u32 s32, s10, s69
    s_addc_u32 s33, s11, 0
    s_mov_b32 s34, 0x1000000
    s_mov_b32 s35, 0x00020000
    s_add_u32 s36, s12, s69
    s_addc_u32 s37, s13, 0
    s_mov_b32 s38, 0x1000000
    s_mov_b32 s39, 0x00020000
    s_mov_b32 s52, s30
    s_mov_b32 s53, s31
    s_mov_b32 s54, 0x600000
    s_mov_b32 s55, 0x00020000
    s_mov_b32 s64, s28
    s_mov_b32 s65, s29
    s_mov_b32 s66, 0x100
    s_mov_b32 s67, 0x00020000
    s_mov_b32 s56, s26
    s_mov_b32 s57, s27
    s_mov_b32 s58, 0x480
    s_mov_b32 s59, 0x00020000
    s_mov_b32 s48, s16
    s_mov_b32 s49, s17
    s_mov_b32 s50, 0x480000
    s_mov_b32 s51, 0x00020000
    s_mov_b32 s44, s24
    s_mov_b32 s45, s25
    s_mov_b32 s46, 0x510000
    s_mov_b32 s47, 0x00020000
    s_cmp_eq_u32 s68, 0
    s_cbranch_scc1 L_NOBULK
    buffer_load_dwordx4 v[48:51], v2, s[32:35], s73 offen offset:0 nt
    buffer_load_dwordx4 v[52:55], v2, s[32:35], s73 offen offset:1024 nt
    buffer_load_dwordx4 v[56:59], v2, s[32:35], s73 offen offset:2048 nt
    buffer_load_dwordx4 v[60:63], v2, s[32:35], s73 offen offset:3072 nt
    buffer_load_dwordx4 v[64:67], v2, s[36:39], s73 offen offset:0 nt
    buffer_load_dwordx4 v[68:71], v2, s[36:39], s73 offen offset:1024 nt
    buffer_load_dwordx4 v[72:75], v2, s[36:39], s73 offen offset:2048 nt
    buffer_load_dwordx4 v[76:79], v2, s[36:39], s73 offen offset:3072 nt
    s_add_u32 s69, s84, 0
    s_lshr_b32 s69, s69, 2
    s_sub_u32 s70, s69, 72
    s_cmp_lt_u32 s69, 72
    s_cselect_b32 s60, s20, s22
    s_cselect_b32 s61, s21, s23
    s_cselect_b32 s70, s69, s70
    s_lshl_b32 s72, s70, 7
    s_cmp_lt_u32 s69, 144
    s_cselect_b32 s62, 0x510000, 0
    buffer_load_dwordx2 v[130:131], v237, s[60:63], s72 offen nt
    s_add_u32 s72, s72, 147456
    buffer_load_dwordx2 v[132:133], v237, s[60:63], s72 offen nt
    s_add_u32 s72, s72, 147456
    buffer_load_dwordx2 v[134:135], v237, s[60:63], s72 offen nt
    s_add_u32 s72, s72, 147456
    buffer_load_dwordx2 v[136:137], v237, s[60:63], s72 offen nt
    s_add_u32 s72, s72, 147456
    buffer_load_dwordx2 v[138:139], v237, s[60:63], s72 offen nt
    s_add_u32 s72, s72, 147456
    buffer_load_dwordx2 v[140:141], v237, s[60:63], s72 offen nt
    s_add_u32 s72, s72, 147456
    buffer_load_dwordx2 v[142:143], v237, s[60:63], s72 offen nt
    s_add_u32 s72, s72, 147456
    buffer_load_dwordx2 v[144:145], v237, s[60:63], s72 offen nt
    s_add_u32 s72, s72, 147456
    buffer_load_dwordx2 v[146:147], v237, s[60:63], s72 offen nt
    s_add_u32 s69, s84, 256
    s_lshr_b32 s69, s69, 2
    s_sub_u32 s70, s69, 72
    s_cmp_lt_u32 s69, 72
    s_cselect_b32 s60, s20, s22
    s_cselect_b32 s61, s21, s23
    s_cselect_b32 s70, s69, s70
    s_lshl_b32 s72, s70, 7
    s_cmp_lt_u32 s69, 144
    s_cselect_b32 s62, 0x510000, 0
    buffer_load_dwordx2 v[148:149], v237, s[60:63], s72 offen nt
    s_add_u32 s72, s72, 147456
    buffer_load_dwordx2 v[150:151], v237, s[60:63], s72 offen nt
    s_add_u32 s72, s72, 147456
    buffer_load_dwordx2 v[152:153], v237, s[60:63], s72 offen nt
    s_add_u32 s72, s72, 147456
    buffer_load_dwordx2 v[154:155], v237, s[60:63], s72 offen nt
    s_add_u32 s72, s72, 147456
    buffer_load_dwordx2 v[156:157], v237, s[60:63], s72 offen nt
    s_add_u32 s72, s72, 147456
    buffer_load_dwordx2 v[158:159], v237, s[60:63], s72 offen nt
    s_add_u32 s72, s72, 147456
    buffer_load_dwordx2 v[160:161], v237, s[60:63], s72 offen nt
    s_add_u32 s72, s72, 147456
    buffer_load_dwordx2 v[162:163], v237, s[60:63], s72 offen nt
    s_add_u32 s72, s72, 147456
    buffer_load_dwordx2 v[164:165], v237, s[60:63], s72 offen nt
L_NOBULK:
    s_cmp_eq_u32 s68, 0
    s_cbranch_scc1 W0_1
    s_waitcnt vmcnt(35)
    s_branch W1_2
W0_1:
    s_waitcnt vmcnt(9)
W1_2:
    ds_read_u16 v100, v35 offset:0
    ds_read_u16 v101, v35 offset:128
    ds_read_u16 v102, v35 offset:256
    ds_read_u16 v103, v35 offset:384
    ds_read_u16 v104, v35 offset:512
    ds_read_u16 v105, v35 offset:640
    ds_read_u16 v106, v35 offset:768
    ds_read_u16 v107, v35 offset:896
    ds_read_u16 v108, v35 offset:1024
    ds_read_u16 v80, v44 offset:0
    ds_read_u16 v81, v44 offset:32
    ds_read_u16 v82, v44 offset:64
    ds_read_u16 v83, v44 offset:96
    ds_read_u16 v84, v44 offset:128
    ds_read_u16 v85, v44 offset:160
    ds_read_u16 v86, v44 offset:192
    ds_read_u16 v87, v44 offset:224
    ds_read_u16 v88, v44 offset:256
    ds_read_u16 v216, v46 offset:0
    ds_read_u16 v217, v46 offset:32
    ds_read_u16 v218, v46 offset:64
    ds_read_u16 v219, v46 offset:96
    ds_read_u16 v220, v46 offset:128
    ds_read_u16 v221, v46 offset:160
    ds_read_u16 v222, v46 offset:192
    ds_read_u16 v223, v46 offset:224
    ds_read_u16 v224, v46 offset:256
    v_and_b32 v46, 15, v1
    v_lshlrev_b32 v46, 4, v46
    v_and_b32 v45, 16, v1
    v_lshrrev_b32 v45, 1, v45
    v_add_u32 v46, v46, v45
    v_and_b32 v45, 32, v1
    v_lshrrev_b32 v45, 3, v45
    v_add_u32 v46, v46, v45
    s_lshl_b32 s69, s68, 8
    v_add_u32 v46, s69, v46
    s_waitcnt lgkmcnt(0)
    v_lshlrev_b32 v100, 16, v100
    v_lshlrev_b32 v101, 16, v101
    v_lshlrev_b32 v102, 16, v102
    v_lshlrev_b32 v103, 16, v103
    v_lshlrev_b32 v104, 16, v104
    v_lshlrev_b32 v105, 16, v105
    v_lshlrev_b32 v106, 16, v106
    v_lshlrev_b32 v107, 16, v107
    v_lshlrev_b32 v108, 16, v108
    v_add_f32 v35, v100, v101
    v_add_f32 v35, v35, v102
    v_add_f32 v35, v35, v103
    v_add_f32 v35, v35, v104
    v_add_f32 v35, v35, v105
    v_add_f32 v35, v35, v106
    v_add_f32 v35, v35, v107
    v_add_f32 v35, v35, v108
    s_nop 1
    v_add_f32_dpp v35, v35, v35 row_ror:8 row_mask:0xf bank_mask:0xf
    s_nop 1
    v_add_f32_dpp v35, v35, v35 row_ror:4 row_mask:0xf bank_mask:0xf
    s_nop 1
    v_add_f32_dpp v35, v35, v35 row_ror:2 row_mask:0xf bank_mask:0xf
    s_nop 1
    v_add_f32_dpp v35, v35, v35 row_ror:1 row_mask:0xf bank_mask:0xf
    v_mov_b32 v34, v35
    s_nop 1
    v_permlane16_swap_b32 v35, v34
    v_add_f32 v35, v35, v34
    v_mov_b32 v34, v35
    s_nop 1
    v_permlane32_swap_b32 v35, v34
    v_add_f32 v35, v35, v34
    v_mul_f32 v35, 0x3ae38e39, v35
    v_sub_f32 v100, v100, v35
    v_mul_f32 v20, v100, v100
    v_sub_f32 v101, v101, v35
    v_fmac_f32 v20, v101, v101
    v_sub_f32 v102, v102, v35
    v_fmac_f32 v20, v102, v102
    v_sub_f32 v103, v103, v35
    v_fmac_f32 v20, v103, v103
    v_sub_f32 v104, v104, v35
    v_fmac_f32 v20, v104, v104
    v_sub_f32 v105, v105, v35
    v_fmac_f32 v20, v105, v105
    v_sub_f32 v106, v106, v35
    v_fmac_f32 v20, v106, v106
    v_sub_f32 v107, v107, v35
    v_fmac_f32 v20, v107, v107
    v_sub_f32 v108, v108, v35
    v_fmac_f32 v20, v108, v108
    s_nop 1
    v_add_f32_dpp v20, v20, v20 row_ror:8 row_mask:0xf bank_mask:0xf
    s_nop 1
    v_add_f32_dpp v20, v20, v20 row_ror:4 row_mask:0xf bank_mask:0xf
    s_nop 1
    v_add_f32_dpp v20, v20, v20 row_ror:2 row_mask:0xf bank_mask:0xf
    s_nop 1
    v_add_f32_dpp v20, v20, v20 row_ror:1 row_mask:0xf bank_mask:0xf
    v_mov_b32 v34, v20
    s_nop 1
    v_permlane16_swap_b32 v20, v34
    v_add_f32 v20, v20, v34
    v_mov_b32 v34, v20
    s_nop 1
    v_permlane32_swap_b32 v20, v34
    v_add_f32 v20, v20, v34
    v_mul_f32 v20, 0x3ae38e39, v20
    v_cvt_pk_bf16_f32 v35, v35, v35
    v_and_b32 v35, 0xffff0000, v35
    v_cvt_pk_bf16_f32 v20, v20, v20
    v_and_b32 v20, 0xffff0000, v20
    v_add_f32 v20, 0x3727c5ac, v20
    v_cvt_pk_bf16_f32 v20, v20, v20
    v_and_b32 v20, 0xffff0000, v20
    v_sqrt_f32 v20, v20
    s_nop 0
    v_cvt_pk_bf16_f32 v20, v20, v20
    v_and_b32 v20, 0xffff0000, v20
    v_rcp_f32 v21, v20
    v_lshlrev_b32 v80, 16, v80
    v_sub_f32 v80, v80, v35
    v_cvt_pk_bf16_f32 v80, v80, v80
    v_and_b32 v80, 0xffff0000, v80
    v_mul_f32 v90, v80, v21
    v_fma_f32 v80, -v90, v20, v80
    v_fmac_f32 v90, v80, v21
    v_cvt_pk_bf16_f32 v90, v90, v90
    v_and_b32 v80, 0xffff0000, v90
    v_and_b32 v90, 0xffff, v90
    v_lshlrev_b32 v81, 16, v81
    v_sub_f32 v81, v81, v35
    v_cvt_pk_bf16_f32 v81, v81, v81
    v_and_b32 v81, 0xffff0000, v81
    v_mul_f32 v91, v81, v21
    v_fma_f32 v81, -v91, v20, v81
    v_fmac_f32 v91, v81, v21
    v_cvt_pk_bf16_f32 v91, v91, v91
    v_and_b32 v81, 0xffff0000, v91
    v_and_b32 v91, 0xffff, v91
    v_lshlrev_b32 v82, 16, v82
    v_sub_f32 v82, v82, v35
    v_cvt_pk_bf16_f32 v82, v82, v82
    v_and_b32 v82, 0xffff0000, v82
    v_mul_f32 v92, v82, v21
    v_fma_f32 v82, -v92, v20, v82
    v_fmac_f32 v92, v82, v21
    v_cvt_pk_bf16_f32 v92, v92, v92
    v_and_b32 v82, 0xffff0000, v92
    v_and_b32 v92, 0xffff, v92
    v_lshlrev_b32 v83, 16, v83
    v_sub_f32 v83, v83, v35
    v_cvt_pk_bf16_f32 v83, v83, v83
    v_and_b32 v83, 0xffff0000, v83
    v_mul_f32 v93, v83, v21
    v_fma_f32 v83, -v93, v20, v83
    v_fmac_f32 v93, v83, v21
    v_cvt_pk_bf16_f32 v93, v93, v93
    v_and_b32 v83, 0xffff0000, v93
    v_and_b32 v93, 0xffff, v93
    v_lshlrev_b32 v84, 16, v84
    v_sub_f32 v84, v84, v35
    v_cvt_pk_bf16_f32 v84, v84, v84
    v_and_b32 v84, 0xffff0000, v84
    v_mul_f32 v94, v84, v21
    v_fma_f32 v84, -v94, v20, v84
    v_fmac_f32 v94, v84, v21
    v_cvt_pk_bf16_f32 v94, v94, v94
    v_and_b32 v84, 0xffff0000, v94
    v_and_b32 v94, 0xffff, v94
    v_lshlrev_b32 v85, 16, v85
    v_sub_f32 v85, v85, v35
    v_cvt_pk_bf16_f32 v85, v85, v85
    v_and_b32 v85, 0xffff0000, v85
    v_mul_f32 v95, v85, v21
    v_fma_f32 v85, -v95, v20, v85
    v_fmac_f32 v95, v85, v21
    v_cvt_pk_bf16_f32 v95, v95, v95
    v_and_b32 v85, 0xffff0000, v95
    v_and_b32 v95, 0xffff, v95
    v_lshlrev_b32 v86, 16, v86
    v_sub_f32 v86, v86, v35
    v_cvt_pk_bf16_f32 v86, v86, v86
    v_and_b32 v86, 0xffff0000, v86
    v_mul_f32 v96, v86, v21
    v_fma_f32 v86, -v96, v20, v86
    v_fmac_f32 v96, v86, v21
    v_cvt_pk_bf16_f32 v96, v96, v96
    v_and_b32 v86, 0xffff0000, v96
    v_and_b32 v96, 0xffff, v96
    v_lshlrev_b32 v87, 16, v87
    v_sub_f32 v87, v87, v35
    v_cvt_pk_bf16_f32 v87, v87, v87
    v_and_b32 v87, 0xffff0000, v87
    v_mul_f32 v97, v87, v21
    v_fma_f32 v87, -v97, v20, v87
    v_fmac_f32 v97, v87, v21
    v_cvt_pk_bf16_f32 v97, v97, v97
    v_and_b32 v87, 0xffff0000, v97
    v_and_b32 v97, 0xffff, v97
    v_lshlrev_b32 v88, 16, v88
    v_sub_f32 v88, v88, v35
    v_cvt_pk_bf16_f32 v88, v88, v88
    v_and_b32 v88, 0xffff0000, v88
    v_mul_f32 v98, v88, v21
    v_fma_f32 v88, -v98, v20, v88
    v_fmac_f32 v98, v88, v21
    v_cvt_pk_bf16_f32 v98, v98, v98
    v_and_b32 v88, 0xffff0000, v98
    v_and_b32 v98, 0xffff, v98
    s_nop 4
    s_cmp_eq_u32 s68, 0
    s_cbranch_scc1 W0_3
    s_waitcnt vmcnt(26)
    s_branch W1_4
W0_3:
    s_waitcnt vmcnt(0)
W1_4:
    v_dot2_f32_bf16 v22, v112, v90, 0
    v_dot2_f32_bf16 v23, v112, v80, 0
    v_dot2_f32_bf16 v24, v113, v90, 0
    v_dot2_f32_bf16 v25, v113, v80, 0
    v_dot2_f32_bf16 v22, v114, v91, v22
    v_dot2_f32_bf16 v23, v114, v81, v23
    v_dot2_f32_bf16 v24, v115, v91, v24
    v_dot2_f32_bf16 v25, v115, v81, v25
    v_dot2_f32_bf16 v22, v116, v92, v22
    v_dot2_f32_bf16 v23, v116, v82, v23
    v_dot2_f32_bf16 v24, v117, v92, v24
    v_dot2_f32_bf16 v25, v117, v82, v25
    v_dot2_f32_bf16 v22, v118, v93, v22
    v_dot2_f32_bf16 v23, v118, v83, v23
    v_dot2_f32_bf16 v24, v119, v93, v24
    v_dot2_f32_bf16 v25, v119, v83, v25
    v_dot2_f32_bf16 v22, v120, v94, v22
    v_dot2_f32_bf16 v23, v120, v84, v23
    v_dot2_f32_bf16 v24, v121, v94, v24
    v_dot2_f32_bf16 v25, v121, v84, v25
    v_dot2_f32_bf16 v22, v122, v95, v22
    v_dot2_f32_bf16 v23, v122, v85, v23
    v_dot2_f32_bf16 v24, v123, v95, v24
    v_dot2_f32_bf16 v25, v123, v85, v25
    v_dot2_f32_bf16 v22, v124, v96, v22
    v_dot2_f32_bf16 v23, v124, v86, v23
    v_dot2_f32_bf16 v24, v125, v96, v24
    v_dot2_f32_bf16 v25, v125, v86, v25
    v_dot2_f32_bf16 v22, v126, v97, v22
    v_dot2_f32_bf16 v23, v126, v87, v23
    v_dot2_f32_bf16 v24, v127, v97, v24
    v_dot2_f32_bf16 v25, v127, v87, v25
    v_dot2_f32_bf16 v22, v128, v98, v22
    v_dot2_f32_bf16 v23, v128, v88, v23
    v_dot2_f32_bf16 v24, v129, v98, v24
    v_dot2_f32_bf16 v25, v129, v88, v25
    s_nop 0
    v_permlane32_swap_b32 v22, v23
    s_nop 0
    v_permlane32_swap_b32 v24, v25
    v_add_f32 v22, v22, v23
    v_add_f32 v24, v24, v25
    s_nop 1
    v_permlane16_swap_b32 v22, v24
    v_add_f32 v22, v22, v24
    ds_write_b32 v46, v22 offset:5632
    s_waitcnt lgkmcnt(0)
    s_barrier
    s_cmp_lg_u32 s68, 0
    s_cbranch_scc1 L_QP
    v_lshlrev_b32 v45, 2, v1
    ds_read_b32 v22, v45 offset:5632
    ds_read_b32 v23, v45 offset:5888
    ds_read_b32 v24, v45 offset:6144
    ds_read_b32 v25, v45 offset:6400
    s_lshr_b32 s70, s79, 2
    s_mul_i32 s70, s70, 53248
    s_lshl_b32 s69, s78, 10
    s_add_u32 s70, s70, s69
    s_and_b32 s69, s79, 3
    s_lshl_b32 s69, s69, 8
    s_add_u32 s70, s70, s69
    s_waitcnt lgkmcnt(0)
    v_add_f32 v22, v22, v23
    v_add_f32 v24, v24, v25
    v_add_f32 v22, v22, v24
    buffer_store_dword v22, v45, s[52:55], s70 offen sc1
    s_lshl_b32 s69, s78, 4
    v_mov_b32 v45, 1
    s_waitcnt vmcnt(0)
    s_mov_b64 exec, 1
    buffer_atomic_add v45, v47, s[64:67], s69 offen
    s_mov_b64 exec, -1
    buffer_load_dwordx4 v[48:51], v2, s[32:35], s73 offen offset:0 nt
    buffer_load_dwordx4 v[52:55], v2, s[32:35], s73 offen offset:1024 nt
    buffer_load_dwordx4 v[56:59], v2, s[32:35], s73 offen offset:2048 nt
    buffer_load_dwordx4 v[60:63], v2, s[32:35], s73 offen offset:3072 nt
    buffer_load_dwordx4 v[64:67], v2, s[36:39], s73 offen offset:0 nt
    buffer_load_dwordx4 v[68:71], v2, s[36:39], s73 offen offset:1024 nt
    buffer_load_dwordx4 v[72:75], v2, s[36:39], s73 offen offset:2048 nt
    buffer_load_dwordx4 v[76:79], v2, s[36:39], s73 offen offset:3072 nt
    s_add_u32 s69, s84, 0
    s_lshr_b32 s69, s69, 2
    s_sub_u32 s70, s69, 72
    s_cmp_lt_u32 s69, 72
    s_cselect_b32 s60, s20, s22
    s_cselect_b32 s61, s21, s23
    s_cselect_b32 s70, s69, s70
    s_lshl_b32 s72, s70, 7
    s_cmp_lt_u32 s69, 144
    s_cselect_b32 s62, 0x510000, 0
    buffer_load_dwordx2 v[130:131], v237, s[60:63], s72 offen nt
    s_add_u32 s72, s72, 147456
    buffer_load_dwordx2 v[132:133], v237, s[60:63], s72 offen nt
    s_add_u32 s72, s72, 147456
    buffer_load_dwordx2 v[134:135], v237, s[60:63], s72 offen nt
    s_add_u32 s72, s72, 147456
    buffer_load_dwordx2 v[136:137], v237, s[60:63], s72 offen nt
    s_add_u32 s72, s72, 147456
    buffer_load_dwordx2 v[138:139], v237, s[60:63], s72 offen nt
    s_add_u32 s72, s72, 147456
    buffer_load_dwordx2 v[140:141], v237, s[60:63], s72 offen nt
    s_add_u32 s72, s72, 147456
    buffer_load_dwordx2 v[142:143], v237, s[60:63], s72 offen nt
    s_add_u32 s72, s72, 147456
    buffer_load_dwordx2 v[144:145], v237, s[60:63], s72 offen nt
    s_add_u32 s72, s72, 147456
    buffer_load_dwordx2 v[146:147], v237, s[60:63], s72 offen nt
    s_add_u32 s69, s84, 256
    s_lshr_b32 s69, s69, 2
    s_sub_u32 s70, s69, 72
    s_cmp_lt_u32 s69, 72
    s_cselect_b32 s60, s20, s22
    s_cselect_b32 s61, s21, s23
    s_cselect_b32 s70, s69, s70
    s_lshl_b32 s72, s70, 7
    s_cmp_lt_u32 s69, 144
    s_cselect_b32 s62, 0x510000, 0
    buffer_load_dwordx2 v[148:149], v237, s[60:63], s72 offen nt
    s_add_u32 s72, s72, 147456
    buffer_load_dwordx2 v[150:151], v237, s[60:63], s72 offen nt
    s_add_u32 s72, s72, 147456
    buffer_load_dwordx2 v[152:153], v237, s[60:63], s72 offen nt
    s_add_u32 s72, s72, 147456
    buffer_load_dwordx2 v[154:155], v237, s[60:63], s72 offen nt
    s_add_u32 s72, s72, 147456
    buffer_load_dwordx2 v[156:157], v237, s[60:63], s72 offen nt
    s_add_u32 s72, s72, 147456
    buffer_load_dwordx2 v[158:159], v237, s[60:63], s72 offen nt
    s_add_u32 s72, s72, 147456
    buffer_load_dwordx2 v[160:161], v237, s[60:63], s72 offen nt
    s_add_u32 s72, s72, 147456
    buffer_load_dwordx2 v[162:163], v237, s[60:63], s72 offen nt
    s_add_u32 s72, s72, 147456
    buffer_load_dwordx2 v[164:165], v237, s[60:63], s72 offen nt
    s_branch L_QP2
L_QP:
    s_cmp_lg_u32 s68, 1
    s_cbranch_scc1 L_QP2
    v_mov_b32 v40, -1
    v_mov_b32 v41, -1
    v_mov_b32 v42, -1
    v_mov_b32 v43, -1
    s_lshl_b32 s69, s2, 13
    s_add_u32 s69, s69, 0x400000
    buffer_store_dwordx4 v[40:43], v2, s[52:55], s69 offen offset:0 sc1
    buffer_store_dwordx4 v[40:43], v2, s[52:55], s69 offen offset:1024 sc1
    buffer_store_dwordx4 v[40:43], v2, s[52:55], s69 offen offset:2048 sc1
    buffer_store_dwordx4 v[40:43], v2, s[52:55], s69 offen offset:3072 sc1
    s_nop 1
    s_add_u32 s69, s69, 4096
    buffer_store_dwordx4 v[40:43], v2, s[52:55], s69 offen sc1
    s_cmp_lg_u32 s79, 0
    s_cbranch_scc1 L_NOCNT
    s_mov_b64 exec, 1
    buffer_store_dword v47, v47, s[52:55], s82 offen sc1
    s_mov_b64 exec, -1
L_NOCNT:
    s_cmp_ge_u32 s2, 144
    s_cbranch_scc1 L_QP2
    s_lshl_b32 s69, s2, 12
    s_add_u32 s69, s69, 0x100000
    s_add_u32 s70, s69, 0x100000
    buffer_store_dwordx4 v[40:43], v2, s[52:55], s69 offen offset:0 sc1
    buffer_store_dwordx4 v[40:43], v2, s[52:55], s69 offen offset:1024 sc1
    buffer_store_dwordx4 v[40:43], v2, s[52:55], s69 offen offset:2048 sc1
    buffer_store_dwordx4 v[40:43], v2, s[52:55], s69 offen offset:3072 sc1
    buffer_store_dwordx4 v[40:43], v2, s[52:55], s70 offen offset:0 sc1
    buffer_store_dwordx4 v[40:43], v2, s[52:55], s70 offen offset:1024 sc1
    buffer_store_dwordx4 v[40:43], v2, s[52:55], s70 offen offset:2048 sc1
    buffer_store_dwordx4 v[40:43], v2, s[52:55], s70 offen offset:3072 sc1
L_QP2:
    s_add_u32 s69, s84, 512
    s_lshr_b32 s69, s69, 2
    s_sub_u32 s70, s69, 72
    s_cmp_lt_u32 s69, 72
    s_cselect_b32 s60, s20, s22
    s_cselect_b32 s61, s21, s23
    s_cselect_b32 s70, s69, s70
    s_lshl_b32 s72, s70, 7
    s_cmp_lt_u32 s69, 144
    s_cselect_b32 s62, 0x510000, 0
    buffer_load_dwordx2 v[166:167], v237, s[60:63], s72 offen nt
    s_add_u32 s72, s72, 147456
    buffer_load_dwordx2 v[168:169], v237, s[60:63], s72 offen nt
    s_add_u32 s72, s72, 147456
    buffer_load_dwordx2 v[170:171], v237, s[60:63], s72 offen nt
    s_add_u32 s72, s72, 147456
    buffer_load_dwordx2 v[172:173], v237, s[60:63], s72 offen nt
    s_add_u32 s72, s72, 147456
    buffer_load_dwordx2 v[174:175], v237, s[60:63], s72 offen nt
    s_add_u32 s72, s72, 147456
    buffer_load_dwordx2 v[176:177], v237, s[60:63], s72 offen nt
    s_add_u32 s72, s72, 147456
    buffer_load_dwordx2 v[178:179], v237, s[60:63], s72 offen nt
    s_add_u32 s72, s72, 147456
    buffer_load_dwordx2 v[180:181], v237, s[60:63], s72 offen nt
    s_add_u32 s72, s72, 147456
    buffer_load_dwordx2 v[182:183], v237, s[60:63], s72 offen nt
    v_lshlrev_b32 v216, 16, v216
    v_sub_f32 v216, v216, v35
    v_cvt_pk_bf16_f32 v216, v216, v216
    v_and_b32 v216, 0xffff0000, v216
    v_mul_f32 v226, v216, v21
    v_fma_f32 v216, -v226, v20, v216
    v_fmac_f32 v226, v216, v21
    v_cvt_pk_bf16_f32 v226, v226, v226
    v_and_b32 v216, 0xffff0000, v226
    v_and_b32 v226, 0xffff, v226
    v_lshlrev_b32 v217, 16, v217
    v_sub_f32 v217, v217, v35
    v_cvt_pk_bf16_f32 v217, v217, v217
    v_and_b32 v217, 0xffff0000, v217
    v_mul_f32 v227, v217, v21
    v_fma_f32 v217, -v227, v20, v217
    v_fmac_f32 v227, v217, v21
    v_cvt_pk_bf16_f32 v227, v227, v227
    v_and_b32 v217, 0xffff0000, v227
    v_and_b32 v227, 0xffff, v227
    v_lshlrev_b32 v218, 16, v218
    v_sub_f32 v218, v218, v35
    v_cvt_pk_bf16_f32 v218, v218, v218
    v_and_b32 v218, 0xffff0000, v218
    v_mul_f32 v228, v218, v21
    v_fma_f32 v218, -v228, v20, v218
    v_fmac_f32 v228, v218, v21
    v_cvt_pk_bf16_f32 v228, v228, v228
    v_and_b32 v218, 0xffff0000, v228
    v_and_b32 v228, 0xffff, v228
    v_lshlrev_b32 v219, 16, v219
    v_sub_f32 v219, v219, v35
    v_cvt_pk_bf16_f32 v219, v219, v219
    v_and_b32 v219, 0xffff0000, v219
    v_mul_f32 v229, v219, v21
    v_fma_f32 v219, -v229, v20, v219
    v_fmac_f32 v229, v219, v21
    v_cvt_pk_bf16_f32 v229, v229, v229
    v_and_b32 v219, 0xffff0000, v229
    v_and_b32 v229, 0xffff, v229
    v_lshlrev_b32 v220, 16, v220
    v_sub_f32 v220, v220, v35
    v_cvt_pk_bf16_f32 v220, v220, v220
    v_and_b32 v220, 0xffff0000, v220
    v_mul_f32 v230, v220, v21
    v_fma_f32 v220, -v230, v20, v220
    v_fmac_f32 v230, v220, v21
    v_cvt_pk_bf16_f32 v230, v230, v230
    v_and_b32 v220, 0xffff0000, v230
    v_and_b32 v230, 0xffff, v230
    v_lshlrev_b32 v221, 16, v221
    v_sub_f32 v221, v221, v35
    v_cvt_pk_bf16_f32 v221, v221, v221
    v_and_b32 v221, 0xffff0000, v221
    v_mul_f32 v231, v221, v21
    v_fma_f32 v221, -v231, v20, v221
    v_fmac_f32 v231, v221, v21
    v_cvt_pk_bf16_f32 v231, v231, v231
    v_and_b32 v221, 0xffff0000, v231
    v_and_b32 v231, 0xffff, v231
    v_lshlrev_b32 v222, 16, v222
    v_sub_f32 v222, v222, v35
    v_cvt_pk_bf16_f32 v222, v222, v222
    v_and_b32 v222, 0xffff0000, v222
    v_mul_f32 v232, v222, v21
    v_fma_f32 v222, -v232, v20, v222
    v_fmac_f32 v232, v222, v21
    v_cvt_pk_bf16_f32 v232, v232, v232
    v_and_b32 v222, 0xffff0000, v232
    v_and_b32 v232, 0xffff, v232
    v_lshlrev_b32 v223, 16, v223
    v_sub_f32 v223, v223, v35
    v_cvt_pk_bf16_f32 v223, v223, v223
    v_and_b32 v223, 0xffff0000, v223
    v_mul_f32 v233, v223, v21
    v_fma_f32 v223, -v233, v20, v223
    v_fmac_f32 v233, v223, v21
    v_cvt_pk_bf16_f32 v233, v233, v233
    v_and_b32 v223, 0xffff0000, v233
    v_and_b32 v233, 0xffff, v233
    v_lshlrev_b32 v224, 16, v224
    v_sub_f32 v224, v224, v35
    v_cvt_pk_bf16_f32 v224, v224, v224
    v_and_b32 v224, 0xffff0000, v224
    v_mul_f32 v234, v224, v21
    v_fma_f32 v224, -v234, v20, v224
    v_fmac_f32 v234, v224, v21
    v_cvt_pk_bf16_f32 v234, v234, v234
    v_and_b32 v224, 0xffff0000, v234
    v_and_b32 v234, 0xffff, v234
    s_add_u32 s3, s73, 4096
    s_add_u32 s69, s81, 64
    s_mov_b32 s5, s73
    s_and_b32 s73, s69, 7
    s_lshl_b32 s73, s73, 8
    s_lshr_b32 s71, s69, 3
    s_add_u32 s73, s73, s71
    s_lshl_b32 s73, s73, 13
    s_mov_b32 s4, s73
    s_mov_b32 s73, s5
    s_add_u32 s6, s4, 4096
    s_add_u32 s69, s81, 128
    s_mov_b32 s5, s73
    s_and_b32 s73, s69, 7
    s_lshl_b32 s73, s73, 8
    s_lshr_b32 s71, s69, 3
    s_add_u32 s73, s73, s71
    s_lshl_b32 s73, s73, 13
    s_mov_b32 s7, s73
    s_mov_b32 s73, s5
    buffer_load_dwordx4 v[80:83], v2, s[32:35], s3 offen offset:0 nt
    buffer_load_dwordx4 v[84:87], v2, s[32:35], s3 offen offset:1024 nt
    buffer_load_dwordx4 v[88:91], v2, s[32:35], s3 offen offset:2048 nt
    buffer_load_dwordx4 v[92:95], v2, s[32:35], s3 offen offset:3072 nt
    buffer_load_dwordx4 v[96:99], v2, s[36:39], s3 offen offset:0 nt
    buffer_load_dwordx4 v[100:103], v2, s[36:39], s3 offen offset:1024 nt
    buffer_load_dwordx4 v[104:107], v2, s[36:39], s3 offen offset:2048 nt
    buffer_load_dwordx4 v[108:111], v2, s[36:39], s3 offen offset:3072 nt
    s_waitcnt vmcnt(26)
    v_dot2_f32_bf16 v22, v130, v226, 0
    v_dot2_f32_bf16 v23, v130, v216, 0
    v_dot2_f32_bf16 v24, v131, v226, 0
    v_dot2_f32_bf16 v25, v131, v216, 0
    v_dot2_f32_bf16 v22, v132, v227, v22
    v_dot2_f32_bf16 v23, v132, v217, v23
    v_dot2_f32_bf16 v24, v133, v227, v24
    v_dot2_f32_bf16 v25, v133, v217, v25
    v_dot2_f32_bf16 v22, v134, v228, v22
    v_dot2_f32_bf16 v23, v134, v218, v23
    v_dot2_f32_bf16 v24, v135, v228, v24
    v_dot2_f32_bf16 v25, v135, v218, v25
    v_dot2_f32_bf16 v22, v136, v229, v22
    v_dot2_f32_bf16 v23, v136, v219, v23
    v_dot2_f32_bf16 v24, v137, v229, v24
    v_dot2_f32_bf16 v25, v137, v219, v25
    v_dot2_f32_bf16 v22, v138, v230, v22
    v_dot2_f32_bf16 v23, v138, v220, v23
    v_dot2_f32_bf16 v24, v139, v230, v24
    v_dot2_f32_bf16 v25, v139, v220, v25
    v_dot2_f32_bf16 v22, v140, v231, v22
    v_dot2_f32_bf16 v23, v140, v221, v23
    v_dot2_f32_bf16 v24, v141, v231, v24
    v_dot2_f32_bf16 v25, v141, v221, v25
    v_dot2_f32_bf16 v22, v142, v232, v22
    v_dot2_f32_bf16 v23, v142, v222, v23
    v_dot2_f32_bf16 v24, v143, v232, v24
    v_dot2_f32_bf16 v25, v143, v222, v25
    v_dot2_f32_bf16 v22, v144, v233, v22
    v_dot2_f32_bf16 v23, v144, v223, v23
    v_dot2_f32_bf16 v24, v145, v233, v24
    v_dot2_f32_bf16 v25, v145, v223, v25
    v_dot2_f32_bf16 v22, v146, v234, v22
    v_dot2_f32_bf16 v23, v146, v224, v23
    v_dot2_f32_bf16 v24, v147, v234, v24
    v_dot2_f32_bf16 v25, v147, v224, v25
    s_nop 0
    v_permlane32_swap_b32 v22, v23
    s_nop 0
    v_permlane32_swap_b32 v24, v25
    v_add_f32 v22, v22, v23
    v_add_f32 v24, v24, v25
    s_nop 1
    v_permlane16_swap_b32 v22, v24
    v_add_f32 v22, v22, v24
    ds_write_b32 v46, v22 offset:6656
    s_waitcnt vmcnt(17)
    v_dot2_f32_bf16 v22, v148, v226, 0
    v_dot2_f32_bf16 v23, v148, v216, 0
    v_dot2_f32_bf16 v24, v149, v226, 0
    v_dot2_f32_bf16 v25, v149, v216, 0
    v_dot2_f32_bf16 v22, v150, v227, v22
    v_dot2_f32_bf16 v23, v150, v217, v23
    v_dot2_f32_bf16 v24, v151, v227, v24
    v_dot2_f32_bf16 v25, v151, v217, v25
    v_dot2_f32_bf16 v22, v152, v228, v22
    v_dot2_f32_bf16 v23, v152, v218, v23
    v_dot2_f32_bf16 v24, v153, v228, v24
    v_dot2_f32_bf16 v25, v153, v218, v25
    v_dot2_f32_bf16 v22, v154, v229, v22
    v_dot2_f32_bf16 v23, v154, v219, v23
    v_dot2_f32_bf16 v24, v155, v229, v24
    v_dot2_f32_bf16 v25, v155, v219, v25
    v_dot2_f32_bf16 v22, v156, v230, v22
    v_dot2_f32_bf16 v23, v156, v220, v23
    v_dot2_f32_bf16 v24, v157, v230, v24
    v_dot2_f32_bf16 v25, v157, v220, v25
    v_dot2_f32_bf16 v22, v158, v231, v22
    v_dot2_f32_bf16 v23, v158, v221, v23
    v_dot2_f32_bf16 v24, v159, v231, v24
    v_dot2_f32_bf16 v25, v159, v221, v25
    v_dot2_f32_bf16 v22, v160, v232, v22
    v_dot2_f32_bf16 v23, v160, v222, v23
    v_dot2_f32_bf16 v24, v161, v232, v24
    v_dot2_f32_bf16 v25, v161, v222, v25
    v_dot2_f32_bf16 v22, v162, v233, v22
    v_dot2_f32_bf16 v23, v162, v223, v23
    v_dot2_f32_bf16 v24, v163, v233, v24
    v_dot2_f32_bf16 v25, v163, v223, v25
    v_dot2_f32_bf16 v22, v164, v234, v22
    v_dot2_f32_bf16 v23, v164, v224, v23
    v_dot2_f32_bf16 v24, v165, v234, v24
    v_dot2_f32_bf16 v25, v165, v224, v25
    s_nop 0
    v_permlane32_swap_b32 v22, v23
    s_nop 0
    v_permlane32_swap_b32 v24, v25
    v_add_f32 v22, v22, v23
    v_add_f32 v24, v24, v25
    s_nop 1
    v_permlane16_swap_b32 v22, v24
    v_add_f32 v22, v22, v24
    ds_write_b32 v46, v22 offset:7680
    s_waitcnt vmcnt(8)
    s_cmp_eq_u32 s68, 0
    s_cbranch_scc1 L_NOSLB
    buffer_load_dwordx4 v[184:187], v2, s[32:35], s4 offen offset:0 nt
    buffer_load_dwordx4 v[188:191], v2, s[32:35], s4 offen offset:1024 nt
    buffer_load_dwordx4 v[192:195], v2, s[32:35], s4 offen offset:2048 nt
    buffer_load_dwordx4 v[196:199], v2, s[32:35], s4 offen offset:3072 nt
    buffer_load_dwordx4 v[200:203], v2, s[36:39], s4 offen offset:0 nt
    buffer_load_dwordx4 v[204:207], v2, s[36:39], s4 offen offset:1024 nt
    buffer_load_dwordx4 v[208:211], v2, s[36:39], s4 offen offset:2048 nt
    buffer_load_dwordx4 v[212:215], v2, s[36:39], s4 offen offset:3072 nt
L_NOSLB:
    v_dot2_f32_bf16 v22, v166, v226, 0
    v_dot2_f32_bf16 v23, v166, v216, 0
    v_dot2_f32_bf16 v24, v167, v226, 0
    v_dot2_f32_bf16 v25, v167, v216, 0
    v_dot2_f32_bf16 v22, v168, v227, v22
    v_dot2_f32_bf16 v23, v168, v217, v23
    v_dot2_f32_bf16 v24, v169, v227, v24
    v_dot2_f32_bf16 v25, v169, v217, v25
    v_dot2_f32_bf16 v22, v170, v228, v22
    v_dot2_f32_bf16 v23, v170, v218, v23
    v_dot2_f32_bf16 v24, v171, v228, v24
    v_dot2_f32_bf16 v25, v171, v218, v25
    v_dot2_f32_bf16 v22, v172, v229, v22
    v_dot2_f32_bf16 v23, v172, v219, v23
    v_dot2_f32_bf16 v24, v173, v229, v24
    v_dot2_f32_bf16 v25, v173, v219, v25
    v_dot2_f32_bf16 v22, v174, v230, v22
    v_dot2_f32_bf16 v23, v174, v220, v23
    v_dot2_f32_bf16 v24, v175, v230, v24
    v_dot2_f32_bf16 v25, v175, v220, v25
    v_dot2_f32_bf16 v22, v176, v231, v22
    v_dot2_f32_bf16 v23, v176, v221, v23
    v_dot2_f32_bf16 v24, v177, v231, v24
    v_dot2_f32_bf16 v25, v177, v221, v25
    v_dot2_f32_bf16 v22, v178, v232, v22
    v_dot2_f32_bf16 v23, v178, v222, v23
    v_dot2_f32_bf16 v24, v179, v232, v24
    v_dot2_f32_bf16 v25, v179, v222, v25
    v_dot2_f32_bf16 v22, v180, v233, v22
    v_dot2_f32_bf16 v23, v180, v223, v23
    v_dot2_f32_bf16 v24, v181, v233, v24
    v_dot2_f32_bf16 v25, v181, v223, v25
    v_dot2_f32_bf16 v22, v182, v234, v22
    v_dot2_f32_bf16 v23, v182, v224, v23
    v_dot2_f32_bf16 v24, v183, v234, v24
    v_dot2_f32_bf16 v25, v183, v224, v25
    s_nop 0
    v_permlane32_swap_b32 v22, v23
    s_nop 0
    v_permlane32_swap_b32 v24, v25
    v_add_f32 v22, v22, v23
    v_add_f32 v24, v24, v25
    s_nop 1
    v_permlane16_swap_b32 v22, v24
    v_add_f32 v22, v22, v24
    ds_write_b32 v46, v22 offset:8704
    s_cmp_lg_u32 s68, 0
    s_cbranch_scc1 L_WQ
    s_lshl_b32 s70, s78, 10
    s_lshl_b32 s69, s78, 4
    s_mov_b32 s77, 1048576
L_QPOLL:
    buffer_load_dword v45, v47, s[64:67], s69 offen sc1
    s_waitcnt vmcnt(0)
    v_readfirstlane_b32 s71, v45
    s_sub_u32 s77, s77, 1
    s_cbranch_scc1 L_QGO
    s_cmp_ge_u32 s71, 16
    s_cbranch_scc0 L_QPOLL
L_QGO:
    buffer_load_dwordx4 v[22:25], v2, s[52:55], s70 offen sc1
    s_add_u32 s70, s70, 53248
    buffer_load_dwordx4 v[26:29], v2, s[52:55], s70 offen sc1
    s_add_u32 s70, s70, 53248
    buffer_load_dwordx4 v[30:33], v2, s[52:55], s70 offen sc1
    s_add_u32 s70, s70, 53248
    buffer_load_dwordx4 v[34:37], v2, s[52:55], s70 offen sc1
    s_barrier
    buffer_load_dwordx4 v[184:187], v2, s[32:35], s4 offen offset:0 nt
    buffer_load_dwordx4 v[188:191], v2, s[32:35], s4 offen offset:1024 nt
    buffer_load_dwordx4 v[192:195], v2, s[32:35], s4 offen offset:2048 nt
    buffer_load_dwordx4 v[196:199], v2, s[32:35], s4 offen offset:3072 nt
    buffer_load_dwordx4 v[200:203], v2, s[36:39], s4 offen offset:0 nt
    buffer_load_dwordx4 v[204:207], v2, s[36:39], s4 offen offset:1024 nt
    buffer_load_dwordx4 v[208:211], v2, s[36:39], s4 offen offset:2048 nt
    buffer_load_dwordx4 v[212:215], v2, s[36:39], s4 offen offset:3072 nt
    buffer_load_dwordx4 v[120:123], v2, s[32:35], s6 offen offset:0 nt
    buffer_load_dwordx4 v[124:127], v2, s[32:35], s6 offen offset:1024 nt
    buffer_load_dwordx4 v[128:131], v2, s[32:35], s6 offen offset:2048 nt
    buffer_load_dwordx4 v[132:135], v2, s[32:35], s6 offen offset:3072 nt
    buffer_load_dwordx4 v[136:139], v2, s[36:39], s6 offen offset:0 nt
    buffer_load_dwordx4 v[140:143], v2, s[36:39], s6 offen offset:1024 nt
    buffer_load_dwordx4 v[144:147], v2, s[36:39], s6 offen offset:2048 nt
    buffer_load_dwordx4 v[148:151], v2, s[36:39], s6 offen offset:3072 nt
    buffer_load_dwordx4 v[152:155], v2, s[32:35], s7 offen offset:0 nt
    buffer_load_dwordx4 v[156:159], v2, s[32:35], s7 offen offset:1024 nt
    buffer_load_dwordx4 v[160:163], v2, s[32:35], s7 offen offset:2048 nt
    buffer_load_dwordx4 v[164:167], v2, s[32:35], s7 offen offset:3072 nt
    buffer_load_dwordx4 v[168:171], v2, s[36:39], s7 offen offset:0 nt
    buffer_load_dwordx4 v[172:175], v2, s[36:39], s7 offen offset:1024 nt
    buffer_load_dwordx4 v[176:179], v2, s[36:39], s7 offen offset:2048 nt
    buffer_load_dwordx4 v[180:183], v2, s[36:39], s7 offen offset:3072 nt
    v_lshlrev_b32 v44, 3, v1
    s_waitcnt vmcnt(24)
    v_add_f32 v22, v22, v26
    v_add_f32 v30, v30, v34
    v_add_f32 v22, v22, v30
    v_add_f32 v23, v23, v27
    v_add_f32 v31, v31, v35
    v_add_f32 v23, v23, v31
    v_add_f32 v24, v24, v28
    v_add_f32 v32, v32, v36
    v_add_f32 v24, v24, v32
    v_add_f32 v25, v25, v29
    v_add_f32 v33, v33, v37
    v_add_f32 v25, v25, v33
    v_cvt_pk_bf16_f32 v22, v22, v23
    v_cvt_pk_bf16_f32 v23, v24, v25
    ds_write_b64 v44, v[22:23] offset:9984
    s_nop 3
    s_branch L_WQ2
L_WQ:
    s_barrier
    buffer_load_dwordx4 v[120:123], v2, s[32:35], s6 offen offset:0 nt
    buffer_load_dwordx4 v[124:127], v2, s[32:35], s6 offen offset:1024 nt
    buffer_load_dwordx4 v[128:131], v2, s[32:35], s6 offen offset:2048 nt
    buffer_load_dwordx4 v[132:135], v2, s[32:35], s6 offen offset:3072 nt
    buffer_load_dwordx4 v[136:139], v2, s[36:39], s6 offen offset:0 nt
    buffer_load_dwordx4 v[140:143], v2, s[36:39], s6 offen offset:1024 nt
    buffer_load_dwordx4 v[144:147], v2, s[36:39], s6 offen offset:2048 nt
    buffer_load_dwordx4 v[148:151], v2, s[36:39], s6 offen offset:3072 nt
    buffer_load_dwordx4 v[152:155], v2, s[32:35], s7 offen offset:0 nt
    buffer_load_dwordx4 v[156:159], v2, s[32:35], s7 offen offset:1024 nt
    buffer_load_dwordx4 v[160:163], v2, s[32:35], s7 offen offset:2048 nt
    buffer_load_dwordx4 v[164:167], v2, s[32:35], s7 offen offset:3072 nt
    buffer_load_dwordx4 v[168:171], v2, s[36:39], s7 offen offset:0 nt
    buffer_load_dwordx4 v[172:175], v2, s[36:39], s7 offen offset:1024 nt
    buffer_load_dwordx4 v[176:179], v2, s[36:39], s7 offen offset:2048 nt
    buffer_load_dwordx4 v[180:183], v2, s[36:39], s7 offen offset:3072 nt
L_WQ2:
    v_and_b32 v35, 7, v1
    v_lshrrev_b32 v44, 1, v35
    v_and_b32 v45, 1, v35
    v_lshlrev_b32 v45, 4, v45
    v_mov_b32 v46, 0xffff
    v_lshlrev_b32 v46, v45, v46
    v_cmp_eq_u32 vcc, 0, v44
    s_nop 1
    v_cndmask_b32 v12, 0, v46, vcc
    v_cmp_eq_u32 vcc, 1, v44
    s_nop 1
    v_cndmask_b32 v13, 0, v46, vcc
    v_cmp_eq_u32 vcc, 2, v44
    s_nop 1
    v_cndmask_b32 v14, 0, v46, vcc
    v_cmp_eq_u32 vcc, 3, v44
    s_nop 1
    v_cndmask_b32 v15, 0, v46, vcc
    v_mov_b32 v16, 0
    v_mov_b32 v17, 0
    v_mov_b32 v18, 0
    v_mov_b32 v19, 0
    v_mov_b32 v20, 0xff800000
    v_mov_b32 v21, 0
    s_sub_u32 s69, s81, 64
    v_mov_b32 v3, s69
    v_and_b32 v35, 15, v1
    v_lshlrev_b32 v35, 4, v35
    v_and_b32 v44, 8, v1
    v_lshl_add_u32 v35, v44, 5, v35
    v_xor_b32 v44, 256, v35
    s_waitcnt lgkmcnt(0)
    s_barrier
    ds_read_b128 v[4:7], v35 offset:9984
    ds_read_b128 v[8:11], v44 offset:9984
    s_cmp_lg_u32 s68, 1
    s_cbranch_scc1 L_NOPUB
    v_lshlrev_b32 v45, 2, v1
    ds_read_b32 v22, v45 offset:6656
    ds_read_b32 v23, v45 offset:6912
    ds_read_b32 v24, v45 offset:7168
    ds_read_b32 v25, v45 offset:7424
    ds_read_b32 v26, v45 offset:7680
    ds_read_b32 v27, v45 offset:7936
    ds_read_b32 v28, v45 offset:8192
    ds_read_b32 v29, v45 offset:8448
    ds_read_b32 v30, v45 offset:8704
    ds_read_b32 v31, v45 offset:8960
    ds_read_b32 v32, v45 offset:9216
    ds_read_b32 v33, v45 offset:9472
    s_and_b32 s70, s78, 3
    s_mul_i32 s70, s70, 53248
    s_lshr_b32 s69, s84, 2
    s_lshl_b32 s69, s69, 8
    s_add_u32 s70, s70, s69
    s_add_u32 s70, s70, 16384
    s_waitcnt lgkmcnt(0)
    v_add_f32 v22, v22, v23
    v_add_f32 v24, v24, v25
    v_add_f32 v22, v22, v24
    buffer_store_dword v22, v45, s[52:55], s70 offen sc1
    s_add_u32 s70, s70, 16384
    v_add_f32 v26, v26, v27
    v_add_f32 v28, v28, v29
    v_add_f32 v26, v26, v28
    buffer_store_dword v26, v45, s[52:55], s70 offen sc1
    s_add_u32 s70, s70, 16384
    v_add_f32 v30, v30, v31
    v_add_f32 v32, v32, v33
    v_add_f32 v30, v30, v32
    s_cmp_ge_u32 s84, 64
    s_cbranch_scc1 L_NOPUB
    buffer_store_dword v30, v45, s[52:55], s70 offen sc1
    s_add_u32 s70, s70, 16384
L_NOPUB:
    s_waitcnt lgkmcnt(0)
    v_mov_b32 v242, -16
    s_add_u32 s73, s7, 4096
    s_mov_b32 s83, 0
    s_mov_b32 s74, 2
    v_dot2_f32_bf16 v22, v48, v4, 0
    v_dot2_f32_bf16 v23, v52, v4, 0
    v_dot2_f32_bf16 v24, v56, v4, 0
    v_dot2_f32_bf16 v25, v60, v4, 0
    v_dot2_f32_bf16 v26, v48, v8, 0
    v_dot2_f32_bf16 v27, v52, v8, 0
    v_dot2_f32_bf16 v28, v56, v8, 0
    v_dot2_f32_bf16 v29, v60, v8, 0
    v_dot2_f32_bf16 v22, v49, v5, v22
    v_dot2_f32_bf16 v23, v53, v5, v23
    v_dot2_f32_bf16 v24, v57, v5, v24
    v_dot2_f32_bf16 v25, v61, v5, v25
    v_dot2_f32_bf16 v26, v49, v9, v26
    v_dot2_f32_bf16 v27, v53, v9, v27
    v_dot2_f32_bf16 v28, v57, v9, v28
    v_dot2_f32_bf16 v29, v61, v9, v29
    v_dot2_f32_bf16 v22, v50, v6, v22
    v_dot2_f32_bf16 v23, v54, v6, v23
    v_dot2_f32_bf16 v24, v58, v6, v24
    v_dot2_f32_bf16 v25, v62, v6, v25
    v_dot2_f32_bf16 v26, v50, v10, v26
    v_dot2_f32_bf16 v27, v54, v10, v27
    v_dot2_f32_bf16 v28, v58, v10, v28
    v_dot2_f32_bf16 v29, v62, v10, v29
    v_dot2_f32_bf16 v22, v51, v7, v22
    v_dot2_f32_bf16 v23, v55, v7, v23
    v_dot2_f32_bf16 v24, v59, v7, v24
    v_dot2_f32_bf16 v25, v63, v7, v25
    v_dot2_f32_bf16 v26, v51, v11, v26
    v_dot2_f32_bf16 v27, v55, v11, v27
    v_dot2_f32_bf16 v28, v59, v11, v28
    v_dot2_f32_bf16 v29, v63, v11, v29
    buffer_load_dwordx4 v[48:51], v2, s[32:35], s73 offen offset:0 nt
    buffer_load_dwordx4 v[52:55], v2, s[32:35], s73 offen offset:1024 nt
    buffer_load_dwordx4 v[56:59], v2, s[32:35], s73 offen offset:2048 nt
    buffer_load_dwordx4 v[60:63], v2, s[32:35], s73 offen offset:3072 nt
    v_add_f32_dpp v22, v26, v22 row_ror:8 row_mask:0xf bank_mask:0xf
    v_add_f32_dpp v23, v27, v23 row_ror:8 row_mask:0xf bank_mask:0xf
    v_add_f32_dpp v24, v28, v24 row_ror:8 row_mask:0xf bank_mask:0xf
    v_add_f32_dpp v25, v29, v25 row_ror:8 row_mask:0xf bank_mask:0xf
    v_add_f32_dpp v22, v22, v22 row_half_mirror row_mask:0xf bank_mask:0xf
    v_add_f32_dpp v23, v23, v23 row_half_mirror row_mask:0xf bank_mask:0xf
    v_add_f32_dpp v24, v24, v24 row_half_mirror row_mask:0xf bank_mask:0xf
    v_add_f32_dpp v25, v25, v25 row_half_mirror row_mask:0xf bank_mask:0xf
    v_add_f32_dpp v22, v22, v22 quad_perm:[1,0,3,2] row_mask:0xf bank_mask:0xf
    v_add_f32_dpp v23, v23, v23 quad_perm:[1,0,3,2] row_mask:0xf bank_mask:0xf
    v_add_f32_dpp v24, v24, v24 quad_perm:[1,0,3,2] row_mask:0xf bank_mask:0xf
    v_add_f32_dpp v25, v25, v25 quad_perm:[1,0,3,2] row_mask:0xf bank_mask:0xf
    v_add_f32_dpp v22, v22, v22 quad_perm:[2,3,0,1] row_mask:0xf bank_mask:0xf
    v_add_f32_dpp v23, v23, v23 quad_perm:[2,3,0,1] row_mask:0xf bank_mask:0xf
    v_add_f32_dpp v24, v24, v24 quad_perm:[2,3,0,1] row_mask:0xf bank_mask:0xf
    v_add_f32_dpp v25, v25, v25 quad_perm:[2,3,0,1] row_mask:0xf bank_mask:0xf
    v_cvt_pk_bf16_f32 v26, v22, v23
    v_cvt_pk_bf16_f32 v27, v24, v25
    v_lshlrev_b32 v22, 16, v26
    v_and_b32 v23, 0xffff0000, v26
    v_lshlrev_b32 v24, 16, v27
    v_and_b32 v25, 0xffff0000, v27
    v_mul_f32 v22, s76, v22
    v_mul_f32 v23, s76, v23
    v_mul_f32 v24, s76, v24
    v_mul_f32 v25, s76, v25
    v_cvt_pk_bf16_f32 v26, v22, v23
    v_cvt_pk_bf16_f32 v27, v24, v25
    v_lshlrev_b32 v22, 16, v26
    v_and_b32 v23, 0xffff0000, v26
    v_lshlrev_b32 v24, 16, v27
    v_and_b32 v25, 0xffff0000, v27
    v_max3_f32 v35, v22, v23, v24
    v_max3_f32 v35, v35, v25, v20
    v_mov_b32 v44, v35
    s_nop 1
    v_permlane16_swap_b32 v35, v44
    v_max_f32 v35, v35, v44
    v_mov_b32 v44, v35
    s_nop 1
    v_permlane32_swap_b32 v35, v44
    v_max_f32 v35, v35, v44
    v_sub_f32 v34, v20, v35
    v_mov_b32 v20, v35
    v_mul_f32 v34, s75, v34
    v_mul_f32 v35, s75, v35
    v_exp_f32 v34, v34
    v_fma_f32 v22, v22, s75, -v35
    v_fma_f32 v23, v23, s75, -v35
    v_fma_f32 v24, v24, s75, -v35
    v_fma_f32 v25, v25, s75, -v35
    v_exp_f32 v22, v22
    v_exp_f32 v23, v23
    v_exp_f32 v24, v24
    v_exp_f32 v25, v25
    v_add_f32 v35, v22, v23
    v_add_f32 v44, v24, v25
    v_cvt_pk_bf16_f32 v30, v22, v22
    v_cvt_pk_bf16_f32 v31, v23, v23
    v_cvt_pk_bf16_f32 v32, v24, v24
    v_cvt_pk_bf16_f32 v33, v25, v25
    v_add_f32 v35, v35, v44
    v_fma_f32 v21, v21, v34, v35
    v_mul_f32 v16, v16, v34
    v_mul_f32 v17, v17, v34
    v_mul_f32 v18, v18, v34
    v_mul_f32 v19, v19, v34
    v_and_b32 v36, v30, v12
    v_and_b32 v37, v30, v13
    v_and_b32 v38, v30, v14
    v_and_b32 v39, v30, v15
    s_nop 1
    v_mfma_f32_16x16x32_bf16 v[16:19], v[64:67], v[36:39], v[16:19]
    v_and_b32 v40, v31, v12
    v_and_b32 v41, v31, v13
    v_and_b32 v42, v31, v14
    v_and_b32 v43, v31, v15
    s_nop 1
    v_mfma_f32_16x16x32_bf16 v[16:19], v[68:71], v[40:43], v[16:19]
    v_and_b32 v36, v32, v12
    v_and_b32 v37, v32, v13
    v_and_b32 v38, v32, v14
    v_and_b32 v39, v32, v15
    s_nop 1
    v_mfma_f32_16x16x32_bf16 v[16:19], v[72:75], v[36:39], v[16:19]
    v_and_b32 v40, v33, v12
    v_and_b32 v41, v33, v13
    v_and_b32 v42, v33, v14
    v_and_b32 v43, v33, v15
    s_nop 1
    v_mfma_f32_16x16x32_bf16 v[16:19], v[76:79], v[40:43], v[16:19]
    buffer_load_dwordx4 v[64:67], v2, s[36:39], s73 offen offset:0 nt
    buffer_load_dwordx4 v[68:71], v2, s[36:39], s73 offen offset:1024 nt
    buffer_load_dwordx4 v[72:75], v2, s[36:39], s73 offen offset:2048 nt
    buffer_load_dwordx4 v[76:79], v2, s[36:39], s73 offen offset:3072 nt
    s_waitcnt vmcnt(36)
    v_dot2_f32_bf16 v22, v80, v4, 0
    v_dot2_f32_bf16 v23, v84, v4, 0
    v_dot2_f32_bf16 v24, v88, v4, 0
    v_dot2_f32_bf16 v25, v92, v4, 0
    v_dot2_f32_bf16 v26, v80, v8, 0
    v_dot2_f32_bf16 v27, v84, v8, 0
    v_dot2_f32_bf16 v28, v88, v8, 0
    v_dot2_f32_bf16 v29, v92, v8, 0
    v_dot2_f32_bf16 v22, v81, v5, v22
    v_dot2_f32_bf16 v23, v85, v5, v23
    v_dot2_f32_bf16 v24, v89, v5, v24
    v_dot2_f32_bf16 v25, v93, v5, v25
    v_dot2_f32_bf16 v26, v81, v9, v26
    v_dot2_f32_bf16 v27, v85, v9, v27
    v_dot2_f32_bf16 v28, v89, v9, v28
    v_dot2_f32_bf16 v29, v93, v9, v29
    v_dot2_f32_bf16 v22, v82, v6, v22
    v_dot2_f32_bf16 v23, v86, v6, v23
    v_dot2_f32_bf16 v24, v90, v6, v24
    v_dot2_f32_bf16 v25, v94, v6, v25
    v_dot2_f32_bf16 v26, v82, v10, v26
    v_dot2_f32_bf16 v27, v86, v10, v27
    v_dot2_f32_bf16 v28, v90, v10, v28
    v_dot2_f32_bf16 v29, v94, v10, v29
    v_dot2_f32_bf16 v22, v83, v7, v22
    v_dot2_f32_bf16 v23, v87, v7, v23
    v_dot2_f32_bf16 v24, v91, v7, v24
    v_dot2_f32_bf16 v25, v95, v7, v25
    v_dot2_f32_bf16 v26, v83, v11, v26
    v_dot2_f32_bf16 v27, v87, v11, v27
    v_dot2_f32_bf16 v28, v91, v11, v28
    v_dot2_f32_bf16 v29, v95, v11, v29
    v_add_f32_dpp v22, v26, v22 row_ror:8 row_mask:0xf bank_mask:0xf
    v_add_f32_dpp v23, v27, v23 row_ror:8 row_mask:0xf bank_mask:0xf
    v_add_f32_dpp v24, v28, v24 row_ror:8 row_mask:0xf bank_mask:0xf
    v_add_f32_dpp v25, v29, v25 row_ror:8 row_mask:0xf bank_mask:0xf
    v_add_f32_dpp v22, v22, v22 row_half_mirror row_mask:0xf bank_mask:0xf
    v_add_f32_dpp v23, v23, v23 row_half_mirror row_mask:0xf bank_mask:0xf
    v_add_f32_dpp v24, v24, v24 row_half_mirror row_mask:0xf bank_mask:0xf
    v_add_f32_dpp v25, v25, v25 row_half_mirror row_mask:0xf bank_mask:0xf
    v_add_f32_dpp v22, v22, v22 quad_perm:[1,0,3,2] row_mask:0xf bank_mask:0xf
    v_add_f32_dpp v23, v23, v23 quad_perm:[1,0,3,2] row_mask:0xf bank_mask:0xf
    v_add_f32_dpp v24, v24, v24 quad_perm:[1,0,3,2] row_mask:0xf bank_mask:0xf
    v_add_f32_dpp v25, v25, v25 quad_perm:[1,0,3,2] row_mask:0xf bank_mask:0xf
    v_add_f32_dpp v22, v22, v22 quad_perm:[2,3,0,1] row_mask:0xf bank_mask:0xf
    v_add_f32_dpp v23, v23, v23 quad_perm:[2,3,0,1] row_mask:0xf bank_mask:0xf
    v_add_f32_dpp v24, v24, v24 quad_perm:[2,3,0,1] row_mask:0xf bank_mask:0xf
    v_add_f32_dpp v25, v25, v25 quad_perm:[2,3,0,1] row_mask:0xf bank_mask:0xf
    v_cvt_pk_bf16_f32 v26, v22, v23
    v_cvt_pk_bf16_f32 v27, v24, v25
    v_lshlrev_b32 v22, 16, v26
    v_and_b32 v23, 0xffff0000, v26
    v_lshlrev_b32 v24, 16, v27
    v_and_b32 v25, 0xffff0000, v27
    v_mul_f32 v22, s76, v22
    v_mul_f32 v23, s76, v23
    v_mul_f32 v24, s76, v24
    v_mul_f32 v25, s76, v25
    v_cvt_pk_bf16_f32 v26, v22, v23
    v_cvt_pk_bf16_f32 v27, v24, v25
    v_lshlrev_b32 v22, 16, v26
    v_and_b32 v23, 0xffff0000, v26
    v_lshlrev_b32 v24, 16, v27
    v_and_b32 v25, 0xffff0000, v27
    v_max3_f32 v35, v22, v23, v24
    v_max3_f32 v35, v35, v25, v20
    v_mov_b32 v44, v35
    s_nop 1
    v_permlane16_swap_b32 v35, v44
    v_max_f32 v35, v35, v44
    v_mov_b32 v44, v35
    s_nop 1
    v_permlane32_swap_b32 v35, v44
    v_max_f32 v35, v35, v44
    v_sub_f32 v34, v20, v35
    v_mov_b32 v20, v35
    v_mul_f32 v34, s75, v34
    v_mul_f32 v35, s75, v35
    v_exp_f32 v34, v34
    v_fma_f32 v22, v22, s75, -v35
    v_fma_f32 v23, v23, s75, -v35
    v_fma_f32 v24, v24, s75, -v35
    v_fma_f32 v25, v25, s75, -v35
    v_exp_f32 v22, v22
    v_exp_f32 v23, v23
    v_exp_f32 v24, v24
    v_exp_f32 v25, v25
    v_add_f32 v35, v22, v23
    v_add_f32 v44, v24, v25
    v_cvt_pk_bf16_f32 v30, v22, v22
    v_cvt_pk_bf16_f32 v31, v23, v23
    v_cvt_pk_bf16_f32 v32, v24, v24
    v_cvt_pk_bf16_f32 v33, v25, v25
    v_add_f32 v35, v35, v44
    v_fma_f32 v21, v21, v34, v35
    v_mul_f32 v16, v16, v34
    v_mul_f32 v17, v17, v34
    v_mul_f32 v18, v18, v34
    v_mul_f32 v19, v19, v34
    s_waitcnt vmcnt(32)
    v_and_b32 v36, v30, v12
    v_and_b32 v37, v30, v13
    v_and_b32 v38, v30, v14
    v_and_b32 v39, v30, v15
    s_nop 1
    v_mfma_f32_16x16x32_bf16 v[16:19], v[96:99], v[36:39], v[16:19]
    v_and_b32 v40, v31, v12
    v_and_b32 v41, v31, v13
    v_and_b32 v42, v31, v14
    v_and_b32 v43, v31, v15
    s_nop 1
    v_mfma_f32_16x16x32_bf16 v[16:19], v[100:103], v[40:43], v[16:19]
    v_and_b32 v36, v32, v12
    v_and_b32 v37, v32, v13
    v_and_b32 v38, v32, v14
    v_and_b32 v39, v32, v15
    s_nop 1
    v_mfma_f32_16x16x32_bf16 v[16:19], v[104:107], v[36:39], v[16:19]
    v_and_b32 v40, v33, v12
    v_and_b32 v41, v33, v13
    v_and_b32 v42, v33, v14
    v_and_b32 v43, v33, v15
    s_nop 1
    v_mfma_f32_16x16x32_bf16 v[16:19], v[108:111], v[40:43], v[16:19]
    s_mov_b32 s3, 3
    s_nop 6
.p2align 6
L_LOOP:
    s_waitcnt vmcnt(4)
    s_cmp_eq_u32 s83, 0
    s_cbranch_scc1 L_NEWID
    s_add_u32 s73, s73, 4096
    s_mov_b32 s83, 0
L_GODUM:
    buffer_load_dword v243, v242, s[52:55], 0 offen
L_GO:
    v_dot2_f32_bf16 v22, v48, v4, 0
    v_dot2_f32_bf16 v23, v52, v4, 0
    v_dot2_f32_bf16 v24, v56, v4, 0
    v_dot2_f32_bf16 v25, v60, v4, 0
    v_dot2_f32_bf16 v26, v48, v8, 0
    v_dot2_f32_bf16 v27, v52, v8, 0
    v_dot2_f32_bf16 v28, v56, v8, 0
    v_dot2_f32_bf16 v29, v60, v8, 0
    v_dot2_f32_bf16 v22, v49, v5, v22
    v_dot2_f32_bf16 v23, v53, v5, v23
    v_dot2_f32_bf16 v24, v57, v5, v24
    v_dot2_f32_bf16 v25, v61, v5, v25
    v_dot2_f32_bf16 v26, v49, v9, v26
    v_dot2_f32_bf16 v27, v53, v9, v27
    v_dot2_f32_bf16 v28, v57, v9, v28
    v_dot2_f32_bf16 v29, v61, v9, v29
    v_dot2_f32_bf16 v22, v50, v6, v22
    v_dot2_f32_bf16 v23, v54, v6, v23
    v_dot2_f32_bf16 v24, v58, v6, v24
    v_dot2_f32_bf16 v25, v62, v6, v25
    v_dot2_f32_bf16 v26, v50, v10, v26
    v_dot2_f32_bf16 v27, v54, v10, v27
    v_dot2_f32_bf16 v28, v58, v10, v28
    v_dot2_f32_bf16 v29, v62, v10, v29
    v_dot2_f32_bf16 v22, v51, v7, v22
    v_dot2_f32_bf16 v23, v55, v7, v23
    v_dot2_f32_bf16 v24, v59, v7, v24
    v_dot2_f32_bf16 v25, v63, v7, v25
    v_dot2_f32_bf16 v26, v51, v11, v26
    v_dot2_f32_bf16 v27, v55, v11, v27
    v_dot2_f32_bf16 v28, v59, v11, v28
    v_dot2_f32_bf16 v29, v63, v11, v29
    buffer_load_dwordx4 v[48:51], v2, s[32:35], s73 offen offset:0 nt
    buffer_load_dwordx4 v[52:55], v2, s[32:35], s73 offen offset:1024 nt
    buffer_load_dwordx4 v[56:59], v2, s[32:35], s73 offen offset:2048 nt
    buffer_load_dwordx4 v[60:63], v2, s[32:35], s73 offen offset:3072 nt
    v_add_f32_dpp v22, v26, v22 row_ror:8 row_mask:0xf bank_mask:0xf
    v_add_f32_dpp v23, v27, v23 row_ror:8 row_mask:0xf bank_mask:0xf
    v_add_f32_dpp v24, v28, v24 row_ror:8 row_mask:0xf bank_mask:0xf
    v_add_f32_dpp v25, v29, v25 row_ror:8 row_mask:0xf bank_mask:0xf
    v_add_f32_dpp v22, v22, v22 row_half_mirror row_mask:0xf bank_mask:0xf
    v_add_f32_dpp v23, v23, v23 row_half_mirror row_mask:0xf bank_mask:0xf
    v_add_f32_dpp v24, v24, v24 row_half_mirror row_mask:0xf bank_mask:0xf
    v_add_f32_dpp v25, v25, v25 row_half_mirror row_mask:0xf bank_mask:0xf
    v_add_f32_dpp v22, v22, v22 quad_perm:[1,0,3,2] row_mask:0xf bank_mask:0xf
    v_add_f32_dpp v23, v23, v23 quad_perm:[1,0,3,2] row_mask:0xf bank_mask:0xf
    v_add_f32_dpp v24, v24, v24 quad_perm:[1,0,3,2] row_mask:0xf bank_mask:0xf
    v_add_f32_dpp v25, v25, v25 quad_perm:[1,0,3,2] row_mask:0xf bank_mask:0xf
    v_add_f32_dpp v22, v22, v22 quad_perm:[2,3,0,1] row_mask:0xf bank_mask:0xf
    v_add_f32_dpp v23, v23, v23 quad_perm:[2,3,0,1] row_mask:0xf bank_mask:0xf
    v_add_f32_dpp v24, v24, v24 quad_perm:[2,3,0,1] row_mask:0xf bank_mask:0xf
    v_add_f32_dpp v25, v25, v25 quad_perm:[2,3,0,1] row_mask:0xf bank_mask:0xf
    v_cvt_pk_bf16_f32 v26, v22, v23
    v_cvt_pk_bf16_f32 v27, v24, v25
    v_lshlrev_b32 v22, 16, v26
    v_and_b32 v23, 0xffff0000, v26
    v_lshlrev_b32 v24, 16, v27
    v_and_b32 v25, 0xffff0000, v27
    v_mul_f32 v22, s76, v22
    v_mul_f32 v23, s76, v23
    v_mul_f32 v24, s76, v24
    v_mul_f32 v25, s76, v25
    v_cvt_pk_bf16_f32 v26, v22, v23
    v_cvt_pk_bf16_f32 v27, v24, v25
    v_lshlrev_b32 v22, 16, v26
    v_and_b32 v23, 0xffff0000, v26
    v_lshlrev_b32 v24, 16, v27
    v_and_b32 v25, 0xffff0000, v27
    v_max3_f32 v35, v22, v23, v24
    v_max3_f32 v35, v35, v25, v20
    v_mov_b32 v44, v35
    s_nop 1
    v_permlane16_swap_b32 v35, v44
    v_max_f32 v35, v35, v44
    v_mov_b32 v44, v35
    s_nop 1
    v_permlane32_swap_b32 v35, v44
    v_max_f32 v35, v35, v44
    v_sub_f32 v34, v20, v35
    v_mov_b32 v20, v35
    v_mul_f32 v34, s75, v34
    v_mul_f32 v35, s75, v35
    v_exp_f32 v34, v34
    v_fma_f32 v22, v22, s75, -v35
    v_fma_f32 v23, v23, s75, -v35
    v_fma_f32 v24, v24, s75, -v35
    v_fma_f32 v25, v25, s75, -v35
    v_exp_f32 v22, v22
    v_exp_f32 v23, v23
    v_exp_f32 v24, v24
    v_exp_f32 v25, v25
    v_add_f32 v35, v22, v23
    v_add_f32 v44, v24, v25
    v_cvt_pk_bf16_f32 v30, v22, v22
    v_cvt_pk_bf16_f32 v31, v23, v23
    v_cvt_pk_bf16_f32 v32, v24, v24
    v_cvt_pk_bf16_f32 v33, v25, v25
    v_add_f32 v35, v35, v44
    v_fma_f32 v21, v21, v34, v35
    v_mul_f32 v16, v16, v34
    v_mul_f32 v17, v17, v34
    v_mul_f32 v18, v18, v34
    v_mul_f32 v19, v19, v34
    s_waitcnt vmcnt(5)
    v_and_b32 v36, v30, v12
    v_and_b32 v37, v30, v13
    v_and_b32 v38, v30, v14
    v_and_b32 v39, v30, v15
    s_nop 1
    v_mfma_f32_16x16x32_bf16 v[16:19], v[64:67], v[36:39], v[16:19]
    v_and_b32 v40, v31, v12
    v_and_b32 v41, v31, v13
    v_and_b32 v42, v31, v14
    v_and_b32 v43, v31, v15
    s_nop 1
    v_mfma_f32_16x16x32_bf16 v[16:19], v[68:71], v[40:43], v[16:19]
    v_and_b32 v36, v32, v12
    v_and_b32 v37, v32, v13
    v_and_b32 v38, v32, v14
    v_and_b32 v39, v32, v15
    s_nop 1
    v_mfma_f32_16x16x32_bf16 v[16:19], v[72:75], v[36:39], v[16:19]
    v_and_b32 v40, v33, v12
    v_and_b32 v41, v33, v13
    v_and_b32 v42, v33, v14
    v_and_b32 v43, v33, v15
    s_nop 1
    v_mfma_f32_16x16x32_bf16 v[16:19], v[76:79], v[40:43], v[16:19]
    buffer_load_dwordx4 v[64:67], v2, s[36:39], s73 offen offset:0 nt
    buffer_load_dwordx4 v[68:71], v2, s[36:39], s73 offen offset:1024 nt
    buffer_load_dwordx4 v[72:75], v2, s[36:39], s73 offen offset:2048 nt
    buffer_load_dwordx4 v[76:79], v2, s[36:39], s73 offen offset:3072 nt
    s_cmp_eq_u32 s3, 0
    s_nop 2
    s_cbranch_scc1 L_LOOP
    s_sub_u32 s3, s3, 1
    s_cmp_lg_u32 s3, 0
    s_cbranch_scc1 L_EX1
    v_dot2_f32_bf16 v22, v184, v4, 0
    v_dot2_f32_bf16 v23, v188, v4, 0
    v_dot2_f32_bf16 v24, v192, v4, 0
    v_dot2_f32_bf16 v25, v196, v4, 0
    v_dot2_f32_bf16 v26, v184, v8, 0
    v_dot2_f32_bf16 v27, v188, v8, 0
    v_dot2_f32_bf16 v28, v192, v8, 0
    v_dot2_f32_bf16 v29, v196, v8, 0
    v_dot2_f32_bf16 v22, v185, v5, v22
    v_dot2_f32_bf16 v23, v189, v5, v23
    v_dot2_f32_bf16 v24, v193, v5, v24
    v_dot2_f32_bf16 v25, v197, v5, v25
    v_dot2_f32_bf16 v26, v185, v9, v26
    v_dot2_f32_bf16 v27, v189, v9, v27
    v_dot2_f32_bf16 v28, v193, v9, v28
    v_dot2_f32_bf16 v29, v197, v9, v29
    v_dot2_f32_bf16 v22, v186, v6, v22
    v_dot2_f32_bf16 v23, v190, v6, v23
    v_dot2_f32_bf16 v24, v194, v6, v24
    v_dot2_f32_bf16 v25, v198, v6, v25
    v_dot2_f32_bf16 v26, v186, v10, v26
    v_dot2_f32_bf16 v27, v190, v10, v27
    v_dot2_f32_bf16 v28, v194, v10, v28
    v_dot2_f32_bf16 v29, v198, v10, v29
    v_dot2_f32_bf16 v22, v187, v7, v22
    v_dot2_f32_bf16 v23, v191, v7, v23
    v_dot2_f32_bf16 v24, v195, v7, v24
    v_dot2_f32_bf16 v25, v199, v7, v25
    v_dot2_f32_bf16 v26, v187, v11, v26
    v_dot2_f32_bf16 v27, v191, v11, v27
    v_dot2_f32_bf16 v28, v195, v11, v28
    v_dot2_f32_bf16 v29, v199, v11, v29
    v_add_f32_dpp v22, v26, v22 row_ror:8 row_mask:0xf bank_mask:0xf
    v_add_f32_dpp v23, v27, v23 row_ror:8 row_mask:0xf bank_mask:0xf
    v_add_f32_dpp v24, v28, v24 row_ror:8 row_mask:0xf bank_mask:0xf
    v_add_f32_dpp v25, v29, v25 row_ror:8 row_mask:0xf bank_mask:0xf
    v_add_f32_dpp v22, v22, v22 row_half_mirror row_mask:0xf bank_mask:0xf
    v_add_f32_dpp v23, v23, v23 row_half_mirror row_mask:0xf bank_mask:0xf
    v_add_f32_dpp v24, v24, v24 row_half_mirror row_mask:0xf bank_mask:0xf
    v_add_f32_dpp v25, v25, v25 row_half_mirror row_mask:0xf bank_mask:0xf
    v_add_f32_dpp v22, v22, v22 quad_perm:[1,0,3,2] row_mask:0xf bank_mask:0xf
    v_add_f32_dpp v23, v23, v23 quad_perm:[1,0,3,2] row_mask:0xf bank_mask:0xf
    v_add_f32_dpp v24, v24, v24 quad_perm:[1,0,3,2] row_mask:0xf bank_mask:0xf
    v_add_f32_dpp v25, v25, v25 quad_perm:[1,0,3,2] row_mask:0xf bank_mask:0xf
    v_add_f32_dpp v22, v22, v22 quad_perm:[2,3,0,1] row_mask:0xf bank_mask:0xf
    v_add_f32_dpp v23, v23, v23 quad_perm:[2,3,0,1] row_mask:0xf bank_mask:0xf
    v_add_f32_dpp v24, v24, v24 quad_perm:[2,3,0,1] row_mask:0xf bank_mask:0xf
    v_add_f32_dpp v25, v25, v25 quad_perm:[2,3,0,1] row_mask:0xf bank_mask:0xf
    v_cvt_pk_bf16_f32 v26, v22, v23
    v_cvt_pk_bf16_f32 v27, v24, v25
    v_lshlrev_b32 v22, 16, v26
    v_and_b32 v23, 0xffff0000, v26
    v_lshlrev_b32 v24, 16, v27
    v_and_b32 v25, 0xffff0000, v27
    v_mul_f32 v22, s76, v22
    v_mul_f32 v23, s76, v23
    v_mul_f32 v24, s76, v24
    v_mul_f32 v25, s76, v25
    v_cvt_pk_bf16_f32 v26, v22, v23
    v_cvt_pk_bf16_f32 v27, v24, v25
    v_lshlrev_b32 v22, 16, v26
    v_and_b32 v23, 0xffff0000, v26
    v_lshlrev_b32 v24, 16, v27
    v_and_b32 v25, 0xffff0000, v27
    v_max3_f32 v35, v22, v23, v24
    v_max3_f32 v35, v35, v25, v20
    v_mov_b32 v44, v35
    s_nop 1
    v_permlane16_swap_b32 v35, v44
    v_max_f32 v35, v35, v44
    v_mov_b32 v44, v35
    s_nop 1
    v_permlane32_swap_b32 v35, v44
    v_max_f32 v35, v35, v44
    v_sub_f32 v34, v20, v35
    v_mov_b32 v20, v35
    v_mul_f32 v34, s75, v34
    v_mul_f32 v35, s75, v35
    v_exp_f32 v34, v34
    v_fma_f32 v22, v22, s75, -v35
    v_fma_f32 v23, v23, s75, -v35
    v_fma_f32 v24, v24, s75, -v35
    v_fma_f32 v25, v25, s75, -v35
    v_exp_f32 v22, v22
    v_exp_f32 v23, v23
    v_exp_f32 v24, v24
    v_exp_f32 v25, v25
    v_add_f32 v35, v22, v23
    v_add_f32 v44, v24, v25
    v_cvt_pk_bf16_f32 v30, v22, v22
    v_cvt_pk_bf16_f32 v31, v23, v23
    v_cvt_pk_bf16_f32 v32, v24, v24
    v_cvt_pk_bf16_f32 v33, v25, v25
    v_add_f32 v35, v35, v44
    v_fma_f32 v21, v21, v34, v35
    v_mul_f32 v16, v16, v34
    v_mul_f32 v17, v17, v34
    v_mul_f32 v18, v18, v34
    v_mul_f32 v19, v19, v34
    v_and_b32 v36, v30, v12
    v_and_b32 v37, v30, v13
    v_and_b32 v38, v30, v14
    v_and_b32 v39, v30, v15
    s_nop 1
    v_mfma_f32_16x16x32_bf16 v[16:19], v[200:203], v[36:39], v[16:19]
    v_and_b32 v40, v31, v12
    v_and_b32 v41, v31, v13
    v_and_b32 v42, v31, v14
    v_and_b32 v43, v31, v15
    s_nop 1
    v_mfma_f32_16x16x32_bf16 v[16:19], v[204:207], v[40:43], v[16:19]
    v_and_b32 v36, v32, v12
    v_and_b32 v37, v32, v13
    v_and_b32 v38, v32, v14
    v_and_b32 v39, v32, v15
    s_nop 1
    v_mfma_f32_16x16x32_bf16 v[16:19], v[208:211], v[36:39], v[16:19]
    v_and_b32 v40, v33, v12
    v_and_b32 v41, v33, v13
    v_and_b32 v42, v33, v14
    v_and_b32 v43, v33, v15
    s_nop 1
    v_mfma_f32_16x16x32_bf16 v[16:19], v[212:215], v[40:43], v[16:19]
    s_nop 7
    s_branch L_LOOP
L_EX1:
    s_cmp_lg_u32 s3, 1
    s_cbranch_scc1 L_EX2
    v_dot2_f32_bf16 v22, v120, v4, 0
    v_dot2_f32_bf16 v23, v124, v4, 0
    v_dot2_f32_bf16 v24, v128, v4, 0
    v_dot2_f32_bf16 v25, v132, v4, 0
    v_dot2_f32_bf16 v26, v120, v8, 0
    v_dot2_f32_bf16 v27, v124, v8, 0
    v_dot2_f32_bf16 v28, v128, v8, 0
    v_dot2_f32_bf16 v29, v132, v8, 0
    v_dot2_f32_bf16 v22, v121, v5, v22
    v_dot2_f32_bf16 v23, v125, v5, v23
    v_dot2_f32_bf16 v24, v129, v5, v24
    v_dot2_f32_bf16 v25, v133, v5, v25
    v_dot2_f32_bf16 v26, v121, v9, v26
    v_dot2_f32_bf16 v27, v125, v9, v27
    v_dot2_f32_bf16 v28, v129, v9, v28
    v_dot2_f32_bf16 v29, v133, v9, v29
    v_dot2_f32_bf16 v22, v122, v6, v22
    v_dot2_f32_bf16 v23, v126, v6, v23
    v_dot2_f32_bf16 v24, v130, v6, v24
    v_dot2_f32_bf16 v25, v134, v6, v25
    v_dot2_f32_bf16 v26, v122, v10, v26
    v_dot2_f32_bf16 v27, v126, v10, v27
    v_dot2_f32_bf16 v28, v130, v10, v28
    v_dot2_f32_bf16 v29, v134, v10, v29
    v_dot2_f32_bf16 v22, v123, v7, v22
    v_dot2_f32_bf16 v23, v127, v7, v23
    v_dot2_f32_bf16 v24, v131, v7, v24
    v_dot2_f32_bf16 v25, v135, v7, v25
    v_dot2_f32_bf16 v26, v123, v11, v26
    v_dot2_f32_bf16 v27, v127, v11, v27
    v_dot2_f32_bf16 v28, v131, v11, v28
    v_dot2_f32_bf16 v29, v135, v11, v29
    v_add_f32_dpp v22, v26, v22 row_ror:8 row_mask:0xf bank_mask:0xf
    v_add_f32_dpp v23, v27, v23 row_ror:8 row_mask:0xf bank_mask:0xf
    v_add_f32_dpp v24, v28, v24 row_ror:8 row_mask:0xf bank_mask:0xf
    v_add_f32_dpp v25, v29, v25 row_ror:8 row_mask:0xf bank_mask:0xf
    v_add_f32_dpp v22, v22, v22 row_half_mirror row_mask:0xf bank_mask:0xf
    v_add_f32_dpp v23, v23, v23 row_half_mirror row_mask:0xf bank_mask:0xf
    v_add_f32_dpp v24, v24, v24 row_half_mirror row_mask:0xf bank_mask:0xf
    v_add_f32_dpp v25, v25, v25 row_half_mirror row_mask:0xf bank_mask:0xf
    v_add_f32_dpp v22, v22, v22 quad_perm:[1,0,3,2] row_mask:0xf bank_mask:0xf
    v_add_f32_dpp v23, v23, v23 quad_perm:[1,0,3,2] row_mask:0xf bank_mask:0xf
    v_add_f32_dpp v24, v24, v24 quad_perm:[1,0,3,2] row_mask:0xf bank_mask:0xf
    v_add_f32_dpp v25, v25, v25 quad_perm:[1,0,3,2] row_mask:0xf bank_mask:0xf
    v_add_f32_dpp v22, v22, v22 quad_perm:[2,3,0,1] row_mask:0xf bank_mask:0xf
    v_add_f32_dpp v23, v23, v23 quad_perm:[2,3,0,1] row_mask:0xf bank_mask:0xf
    v_add_f32_dpp v24, v24, v24 quad_perm:[2,3,0,1] row_mask:0xf bank_mask:0xf
    v_add_f32_dpp v25, v25, v25 quad_perm:[2,3,0,1] row_mask:0xf bank_mask:0xf
    v_cvt_pk_bf16_f32 v26, v22, v23
    v_cvt_pk_bf16_f32 v27, v24, v25
    v_lshlrev_b32 v22, 16, v26
    v_and_b32 v23, 0xffff0000, v26
    v_lshlrev_b32 v24, 16, v27
    v_and_b32 v25, 0xffff0000, v27
    v_mul_f32 v22, s76, v22
    v_mul_f32 v23, s76, v23
    v_mul_f32 v24, s76, v24
    v_mul_f32 v25, s76, v25
    v_cvt_pk_bf16_f32 v26, v22, v23
    v_cvt_pk_bf16_f32 v27, v24, v25
    v_lshlrev_b32 v22, 16, v26
    v_and_b32 v23, 0xffff0000, v26
    v_lshlrev_b32 v24, 16, v27
    v_and_b32 v25, 0xffff0000, v27
    v_max3_f32 v35, v22, v23, v24
    v_max3_f32 v35, v35, v25, v20
    v_mov_b32 v44, v35
    s_nop 1
    v_permlane16_swap_b32 v35, v44
    v_max_f32 v35, v35, v44
    v_mov_b32 v44, v35
    s_nop 1
    v_permlane32_swap_b32 v35, v44
    v_max_f32 v35, v35, v44
    v_sub_f32 v34, v20, v35
    v_mov_b32 v20, v35
    v_mul_f32 v34, s75, v34
    v_mul_f32 v35, s75, v35
    v_exp_f32 v34, v34
    v_fma_f32 v22, v22, s75, -v35
    v_fma_f32 v23, v23, s75, -v35
    v_fma_f32 v24, v24, s75, -v35
    v_fma_f32 v25, v25, s75, -v35
    v_exp_f32 v22, v22
    v_exp_f32 v23, v23
    v_exp_f32 v24, v24
    v_exp_f32 v25, v25
    v_add_f32 v35, v22, v23
    v_add_f32 v44, v24, v25
    v_cvt_pk_bf16_f32 v30, v22, v22
    v_cvt_pk_bf16_f32 v31, v23, v23
    v_cvt_pk_bf16_f32 v32, v24, v24
    v_cvt_pk_bf16_f32 v33, v25, v25
    v_add_f32 v35, v35, v44
    v_fma_f32 v21, v21, v34, v35
    v_mul_f32 v16, v16, v34
    v_mul_f32 v17, v17, v34
    v_mul_f32 v18, v18, v34
    v_mul_f32 v19, v19, v34
    v_and_b32 v36, v30, v12
    v_and_b32 v37, v30, v13
    v_and_b32 v38, v30, v14
    v_and_b32 v39, v30, v15
    s_nop 1
    v_mfma_f32_16x16x32_bf16 v[16:19], v[136:139], v[36:39], v[16:19]
    v_and_b32 v40, v31, v12
    v_and_b32 v41, v31, v13
    v_and_b32 v42, v31, v14
    v_and_b32 v43, v31, v15
    s_nop 1
    v_mfma_f32_16x16x32_bf16 v[16:19], v[140:143], v[40:43], v[16:19]
    v_and_b32 v36, v32, v12
    v_and_b32 v37, v32, v13
    v_and_b32 v38, v32, v14
    v_and_b32 v39, v32, v15
    s_nop 1
    v_mfma_f32_16x16x32_bf16 v[16:19], v[144:147], v[36:39], v[16:19]
    v_and_b32 v40, v33, v12
    v_and_b32 v41, v33, v13
    v_and_b32 v42, v33, v14
    v_and_b32 v43, v33, v15
    s_nop 1
    v_mfma_f32_16x16x32_bf16 v[16:19], v[148:151], v[40:43], v[16:19]
    s_nop 7
    s_branch L_LOOP
L_EX2:
    v_dot2_f32_bf16 v22, v152, v4, 0
    v_dot2_f32_bf16 v23, v156, v4, 0
    v_dot2_f32_bf16 v24, v160, v4, 0
    v_dot2_f32_bf16 v25, v164, v4, 0
    v_dot2_f32_bf16 v26, v152, v8, 0
    v_dot2_f32_bf16 v27, v156, v8, 0
    v_dot2_f32_bf16 v28, v160, v8, 0
    v_dot2_f32_bf16 v29, v164, v8, 0
    v_dot2_f32_bf16 v22, v153, v5, v22
    v_dot2_f32_bf16 v23, v157, v5, v23
    v_dot2_f32_bf16 v24, v161, v5, v24
    v_dot2_f32_bf16 v25, v165, v5, v25
    v_dot2_f32_bf16 v26, v153, v9, v26
    v_dot2_f32_bf16 v27, v157, v9, v27
    v_dot2_f32_bf16 v28, v161, v9, v28
    v_dot2_f32_bf16 v29, v165, v9, v29
    v_dot2_f32_bf16 v22, v154, v6, v22
    v_dot2_f32_bf16 v23, v158, v6, v23
    v_dot2_f32_bf16 v24, v162, v6, v24
    v_dot2_f32_bf16 v25, v166, v6, v25
    v_dot2_f32_bf16 v26, v154, v10, v26
    v_dot2_f32_bf16 v27, v158, v10, v27
    v_dot2_f32_bf16 v28, v162, v10, v28
    v_dot2_f32_bf16 v29, v166, v10, v29
    v_dot2_f32_bf16 v22, v155, v7, v22
    v_dot2_f32_bf16 v23, v159, v7, v23
    v_dot2_f32_bf16 v24, v163, v7, v24
    v_dot2_f32_bf16 v25, v167, v7, v25
    v_dot2_f32_bf16 v26, v155, v11, v26
    v_dot2_f32_bf16 v27, v159, v11, v27
    v_dot2_f32_bf16 v28, v163, v11, v28
    v_dot2_f32_bf16 v29, v167, v11, v29
    v_add_f32_dpp v22, v26, v22 row_ror:8 row_mask:0xf bank_mask:0xf
    v_add_f32_dpp v23, v27, v23 row_ror:8 row_mask:0xf bank_mask:0xf
    v_add_f32_dpp v24, v28, v24 row_ror:8 row_mask:0xf bank_mask:0xf
    v_add_f32_dpp v25, v29, v25 row_ror:8 row_mask:0xf bank_mask:0xf
    v_add_f32_dpp v22, v22, v22 row_half_mirror row_mask:0xf bank_mask:0xf
    v_add_f32_dpp v23, v23, v23 row_half_mirror row_mask:0xf bank_mask:0xf
    v_add_f32_dpp v24, v24, v24 row_half_mirror row_mask:0xf bank_mask:0xf
    v_add_f32_dpp v25, v25, v25 row_half_mirror row_mask:0xf bank_mask:0xf
    v_add_f32_dpp v22, v22, v22 quad_perm:[1,0,3,2] row_mask:0xf bank_mask:0xf
    v_add_f32_dpp v23, v23, v23 quad_perm:[1,0,3,2] row_mask:0xf bank_mask:0xf
    v_add_f32_dpp v24, v24, v24 quad_perm:[1,0,3,2] row_mask:0xf bank_mask:0xf
    v_add_f32_dpp v25, v25, v25 quad_perm:[1,0,3,2] row_mask:0xf bank_mask:0xf
    v_add_f32_dpp v22, v22, v22 quad_perm:[2,3,0,1] row_mask:0xf bank_mask:0xf
    v_add_f32_dpp v23, v23, v23 quad_perm:[2,3,0,1] row_mask:0xf bank_mask:0xf
    v_add_f32_dpp v24, v24, v24 quad_perm:[2,3,0,1] row_mask:0xf bank_mask:0xf
    v_add_f32_dpp v25, v25, v25 quad_perm:[2,3,0,1] row_mask:0xf bank_mask:0xf
    v_cvt_pk_bf16_f32 v26, v22, v23
    v_cvt_pk_bf16_f32 v27, v24, v25
    v_lshlrev_b32 v22, 16, v26
    v_and_b32 v23, 0xffff0000, v26
    v_lshlrev_b32 v24, 16, v27
    v_and_b32 v25, 0xffff0000, v27
    v_mul_f32 v22, s76, v22
    v_mul_f32 v23, s76, v23
    v_mul_f32 v24, s76, v24
    v_mul_f32 v25, s76, v25
    v_cvt_pk_bf16_f32 v26, v22, v23
    v_cvt_pk_bf16_f32 v27, v24, v25
    v_lshlrev_b32 v22, 16, v26
    v_and_b32 v23, 0xffff0000, v26
    v_lshlrev_b32 v24, 16, v27
    v_and_b32 v25, 0xffff0000, v27
    v_max3_f32 v35, v22, v23, v24
    v_max3_f32 v35, v35, v25, v20
    v_mov_b32 v44, v35
    s_nop 1
    v_permlane16_swap_b32 v35, v44
    v_max_f32 v35, v35, v44
    v_mov_b32 v44, v35
    s_nop 1
    v_permlane32_swap_b32 v35, v44
    v_max_f32 v35, v35, v44
    v_sub_f32 v34, v20, v35
    v_mov_b32 v20, v35
    v_mul_f32 v34, s75, v34
    v_mul_f32 v35, s75, v35
    v_exp_f32 v34, v34
    v_fma_f32 v22, v22, s75, -v35
    v_fma_f32 v23, v23, s75, -v35
    v_fma_f32 v24, v24, s75, -v35
    v_fma_f32 v25, v25, s75, -v35
    v_exp_f32 v22, v22
    v_exp_f32 v23, v23
    v_exp_f32 v24, v24
    v_exp_f32 v25, v25
    v_add_f32 v35, v22, v23
    v_add_f32 v44, v24, v25
    v_cvt_pk_bf16_f32 v30, v22, v22
    v_cvt_pk_bf16_f32 v31, v23, v23
    v_cvt_pk_bf16_f32 v32, v24, v24
    v_cvt_pk_bf16_f32 v33, v25, v25
    v_add_f32 v35, v35, v44
    v_fma_f32 v21, v21, v34, v35
    v_mul_f32 v16, v16, v34
    v_mul_f32 v17, v17, v34
    v_mul_f32 v18, v18, v34
    v_mul_f32 v19, v19, v34
    v_and_b32 v36, v30, v12
    v_and_b32 v37, v30, v13
    v_and_b32 v38, v30, v14
    v_and_b32 v39, v30, v15
    s_nop 1
    v_mfma_f32_16x16x32_bf16 v[16:19], v[168:171], v[36:39], v[16:19]
    v_and_b32 v40, v31, v12
    v_and_b32 v41, v31, v13
    v_and_b32 v42, v31, v14
    v_and_b32 v43, v31, v15
    s_nop 1
    v_mfma_f32_16x16x32_bf16 v[16:19], v[172:175], v[40:43], v[16:19]
    v_and_b32 v36, v32, v12
    v_and_b32 v37, v32, v13
    v_and_b32 v38, v32, v14
    v_and_b32 v39, v32, v15
    s_nop 1
    v_mfma_f32_16x16x32_bf16 v[16:19], v[176:179], v[36:39], v[16:19]
    v_and_b32 v40, v33, v12
    v_and_b32 v41, v33, v13
    v_and_b32 v42, v33, v14
    v_and_b32 v43, v33, v15
    s_nop 1
    v_mfma_f32_16x16x32_bf16 v[16:19], v[180:183], v[40:43], v[16:19]
    s_nop 7
    s_branch L_LOOP
L_NEWID:
    s_add_u32 s74, s74, 1
    s_cmp_lt_u32 s74, 25
    s_cbranch_scc1 L_SPECIAL
L_DYN:
    v_readfirstlane_b32 s69, v3
    s_nop 0
    s_add_u32 s69, s69, 1664
    s_cmp_ge_u32 s69, 1920
    s_cbranch_scc1 L_SMALL
    s_mov_b32 s83, 1
    s_and_b32 s73, s69, 7
    s_lshl_b32 s73, s73, 8
    s_lshr_b32 s71, s69, 3
    s_add_u32 s73, s73, s71
    s_lshl_b32 s73, s73, 13
L_ATOM:
    v_mov_b32 v3, 1
    s_mov_b64 exec, 1
    buffer_atomic_add v3, v47, s[52:55], s82 offen sc0
    s_mov_b64 exec, -1
    s_branch L_GO
L_SMALL:
    s_sub_u32 s70, s69, 1920
    s_lshr_b32 s69, s70, 1
    s_add_u32 s69, s69, 1920
    s_cmp_ge_u32 s69, 2048
    s_cbranch_scc1 L_LAST
    s_and_b32 s73, s69, 7
    s_lshl_b32 s73, s73, 8
    s_lshr_b32 s71, s69, 3
    s_add_u32 s73, s73, s71
    s_lshl_b32 s73, s73, 13
    s_and_b32 s70, s70, 1
    s_lshl_b32 s70, s70, 12
    s_add_u32 s73, s73, s70
    s_branch L_ATOM
L_SPECIAL:
    s_cmp_gt_u32 s74, 10
    s_cbranch_scc1 L_SP_ST
    s_cmp_eq_u32 s74, 10
    s_cbranch_scc1 L_SP_PERM
    s_cmp_eq_u32 s74, 9
    s_cbranch_scc1 L_SP_FFN
    s_cmp_eq_u32 s74, 8
    s_cbranch_scc1 L_SP_VER
    s_cmp_lg_u32 s74, 7
    s_cbranch_scc1 L_SP_1
    buffer_load_dword v239, v47, s[64:67], 0 offen offset:8 sc1
L_SP_1:
    s_cmp_lg_u32 s74, 3
    s_cbranch_scc1 L_SP_ST
    s_cmp_lg_u32 s68, 1
    s_cbranch_scc1 L_SP_ST
    v_mov_b32 v45, 1
    s_mov_b64 exec, 1
    buffer_atomic_add v45, v47, s[64:67], 0 offen offset:8
    s_mov_b64 exec, -1
L_SP_ST:
    s_lshl_b32 s69, s74, 6
    s_add_u32 s69, s69, s81
    s_and_b32 s73, s69, 7
    s_lshl_b32 s73, s73, 8
    s_lshr_b32 s71, s69, 3
    s_add_u32 s73, s73, s71
    s_lshl_b32 s73, s73, 13
    s_mov_b32 s83, 1
    s_branch L_GODUM
L_SP_VER:
    v_readfirstlane_b32 s71, v239
    s_mov_b32 s77, 1048576
    s_cmp_ge_u32 s71, 256
    s_cbranch_scc1 L_SP_OK
L_GPOLL:
    buffer_load_dword v239, v47, s[64:67], 0 offen offset:8 sc1
    s_waitcnt vmcnt(0)
    v_readfirstlane_b32 s71, v239
    s_sub_u32 s77, s77, 1
    s_cbranch_scc1 L_SP_OK
    s_cmp_ge_u32 s71, 256
    s_cbranch_scc0 L_GPOLL
L_SP_OK:
    s_mul_i32 s69, s2, 72
    s_add_u32 s69, s69, 16384
    v_lshlrev_b32 v35, 2, v1
    buffer_load_dword v208, v35, s[52:55], s69 offen sc1
    s_add_u32 s70, s69, 18432
    buffer_load_dword v212, v35, s[52:55], s70 offen sc1
    s_add_u32 s69, s69, 53248
    buffer_load_dword v209, v35, s[52:55], s69 offen sc1
    s_add_u32 s70, s69, 18432
    buffer_load_dword v213, v35, s[52:55], s70 offen sc1
    s_add_u32 s69, s69, 53248
    buffer_load_dword v210, v35, s[52:55], s69 offen sc1
    s_add_u32 s70, s69, 18432
    buffer_load_dword v214, v35, s[52:55], s70 offen sc1
    s_add_u32 s69, s69, 53248
    buffer_load_dword v211, v35, s[52:55], s69 offen sc1
    s_add_u32 s70, s69, 18432
    buffer_load_dword v215, v35, s[52:55], s70 offen sc1
    s_branch L_SP_ST
L_SP_FFN:
    v_add_f32 v208, v208, v209
    v_add_f32 v210, v210, v211
    v_add_f32 v208, v208, v210
    v_cvt_pk_bf16_f32 v208, v208, v208
    v_and_b32 v208, 0xffff0000, v208
    v_add_f32 v212, v212, v213
    v_add_f32 v214, v214, v215
    v_add_f32 v212, v212, v214
    v_cvt_pk_bf16_f32 v212, v212, v212
    v_and_b32 v212, 0xffff0000, v212
    v_mul_f32 v209, s75, v208
    v_exp_f32 v209, -v209
    s_nop 0
    v_add_f32 v209, 1.0, v209
    v_rcp_f32 v209, v209
    s_nop 0
    v_mul_f32 v209, v209, v208
    v_cvt_pk_bf16_f32 v209, v209, v209
    v_and_b32 v209, 0xffff0000, v209
    v_mul_f32 v209, v209, v212
    v_cvt_pk_bf16_f32 v209, v209, v209
    v_and_b32 v209, 0xffff0000, v209
    s_nop 4
    s_branch L_SP_ST
L_SP_PERM:
    s_branch L_SP_ST
L_LAST:
    v_and_b32 v236, 8, v1
    v_lshrrev_b32 v237, 4, v1
    v_lshl_add_u32 v236, v237, 1, v236
    v_lshlrev_b32 v236, 13, v236
    v_and_b32 v237, 7, v1
    v_lshl_add_u32 v46, v237, 13, v236
    v_lshl_add_u32 v236, v237, 3, v236
    s_lshl_b32 s69, s78, 17
    s_add_u32 s69, s69, 0x400000
    s_lshl_b32 s70, s81, 6
    s_add_u32 s70, s70, s69
    s_add_u32 s72, s70, 8192
    s_lshl_b32 s71, s81, 3
    s_add_u32 s71, s71, s69
    s_add_u32 s71, s71, 4096
    v_and_b32 v238, 127, v0
    v_lshlrev_b32 v45, 4, v238
    v_cmp_gt_u32 vcc, 72, v238
    s_nop 1
    v_cndmask_b32 v45, -16, v45, vcc
    s_mul_i32 s3, s2, 18432
    s_mul_i32 s4, s2, 20736
    s_cmp_lt_u32 s68, 2
    s_cselect_b32 s3, s3, s4
    s_cselect_b32 s60, s48, s44
    s_cselect_b32 s61, s49, s45
    s_cselect_b32 s62, s50, s46
    s_cselect_b32 s63, s51, s47
    v_dot2_f32_bf16 v22, v48, v4, 0
    v_dot2_f32_bf16 v23, v52, v4, 0
    v_dot2_f32_bf16 v24, v56, v4, 0
    v_dot2_f32_bf16 v25, v60, v4, 0
    v_dot2_f32_bf16 v26, v48, v8, 0
    v_dot2_f32_bf16 v27, v52, v8, 0
    v_dot2_f32_bf16 v28, v56, v8, 0
    v_dot2_f32_bf16 v29, v60, v8, 0
    v_dot2_f32_bf16 v22, v49, v5, v22
    v_dot2_f32_bf16 v23, v53, v5, v23
    v_dot2_f32_bf16 v24, v57, v5, v24
    v_dot2_f32_bf16 v25, v61, v5, v25
    v_dot2_f32_bf16 v26, v49, v9, v26
    v_dot2_f32_bf16 v27, v53, v9, v27
    v_dot2_f32_bf16 v28, v57, v9, v28
    v_dot2_f32_bf16 v29, v61, v9, v29
    v_dot2_f32_bf16 v22, v50, v6, v22
    v_dot2_f32_bf16 v23, v54, v6, v23
    v_dot2_f32_bf16 v24, v58, v6, v24
    v_dot2_f32_bf16 v25, v62, v6, v25
    v_dot2_f32_bf16 v26, v50, v10, v26
    v_dot2_f32_bf16 v27, v54, v10, v27
    v_dot2_f32_bf16 v28, v58, v10, v28
    v_dot2_f32_bf16 v29, v62, v10, v29
    v_dot2_f32_bf16 v22, v51, v7, v22
    v_dot2_f32_bf16 v23, v55, v7, v23
    v_dot2_f32_bf16 v24, v59, v7, v24
    v_dot2_f32_bf16 v25, v63, v7, v25
    v_dot2_f32_bf16 v26, v51, v11, v26
    v_dot2_f32_bf16 v27, v55, v11, v27
    v_dot2_f32_bf16 v28, v59, v11, v28
    v_dot2_f32_bf16 v29, v63, v11, v29
    v_add_f32_dpp v22, v26, v22 row_ror:8 row_mask:0xf bank_mask:0xf
    v_add_f32_dpp v23, v27, v23 row_ror:8 row_mask:0xf bank_mask:0xf
    v_add_f32_dpp v24, v28, v24 row_ror:8 row_mask:0xf bank_mask:0xf
    v_add_f32_dpp v25, v29, v25 row_ror:8 row_mask:0xf bank_mask:0xf
    v_add_f32_dpp v22, v22, v22 row_half_mirror row_mask:0xf bank_mask:0xf
    v_add_f32_dpp v23, v23, v23 row_half_mirror row_mask:0xf bank_mask:0xf
    v_add_f32_dpp v24, v24, v24 row_half_mirror row_mask:0xf bank_mask:0xf
    v_add_f32_dpp v25, v25, v25 row_half_mirror row_mask:0xf bank_mask:0xf
    v_add_f32_dpp v22, v22, v22 quad_perm:[1,0,3,2] row_mask:0xf bank_mask:0xf
    v_add_f32_dpp v23, v23, v23 quad_perm:[1,0,3,2] row_mask:0xf bank_mask:0xf
    v_add_f32_dpp v24, v24, v24 quad_perm:[1,0,3,2] row_mask:0xf bank_mask:0xf
    v_add_f32_dpp v25, v25, v25 quad_perm:[1,0,3,2] row_mask:0xf bank_mask:0xf
    v_add_f32_dpp v22, v22, v22 quad_perm:[2,3,0,1] row_mask:0xf bank_mask:0xf
    v_add_f32_dpp v23, v23, v23 quad_perm:[2,3,0,1] row_mask:0xf bank_mask:0xf
    v_add_f32_dpp v24, v24, v24 quad_perm:[2,3,0,1] row_mask:0xf bank_mask:0xf
    v_add_f32_dpp v25, v25, v25 quad_perm:[2,3,0,1] row_mask:0xf bank_mask:0xf
    v_cvt_pk_bf16_f32 v26, v22, v23
    v_cvt_pk_bf16_f32 v27, v24, v25
    v_lshlrev_b32 v22, 16, v26
    v_and_b32 v23, 0xffff0000, v26
    v_lshlrev_b32 v24, 16, v27
    v_and_b32 v25, 0xffff0000, v27
    v_mul_f32 v22, s76, v22
    v_mul_f32 v23, s76, v23
    v_mul_f32 v24, s76, v24
    v_mul_f32 v25, s76, v25
    v_cvt_pk_bf16_f32 v26, v22, v23
    v_cvt_pk_bf16_f32 v27, v24, v25
    v_lshlrev_b32 v22, 16, v26
    v_and_b32 v23, 0xffff0000, v26
    v_lshlrev_b32 v24, 16, v27
    v_and_b32 v25, 0xffff0000, v27
    v_max3_f32 v35, v22, v23, v24
    v_max3_f32 v35, v35, v25, v20
    v_mov_b32 v44, v35
    s_nop 1
    v_permlane16_swap_b32 v35, v44
    v_max_f32 v35, v35, v44
    v_mov_b32 v44, v35
    s_nop 1
    v_permlane32_swap_b32 v35, v44
    v_max_f32 v35, v35, v44
    v_sub_f32 v34, v20, v35
    v_mov_b32 v20, v35
    v_mul_f32 v34, s75, v34
    v_mul_f32 v35, s75, v35
    v_exp_f32 v34, v34
    v_fma_f32 v22, v22, s75, -v35
    v_fma_f32 v23, v23, s75, -v35
    v_fma_f32 v24, v24, s75, -v35
    v_fma_f32 v25, v25, s75, -v35
    v_exp_f32 v22, v22
    v_exp_f32 v23, v23
    v_exp_f32 v24, v24
    v_exp_f32 v25, v25
    v_add_f32 v35, v22, v23
    v_add_f32 v44, v24, v25
    v_cvt_pk_bf16_f32 v30, v22, v22
    v_cvt_pk_bf16_f32 v31, v23, v23
    v_cvt_pk_bf16_f32 v32, v24, v24
    v_cvt_pk_bf16_f32 v33, v25, v25
    v_add_f32 v35, v35, v44
    v_fma_f32 v21, v21, v34, v35
    v_mul_f32 v16, v16, v34
    v_mul_f32 v17, v17, v34
    v_mul_f32 v18, v18, v34
    v_mul_f32 v19, v19, v34
    s_waitcnt vmcnt(0)
    v_and_b32 v36, v30, v12
    v_and_b32 v37, v30, v13
    v_and_b32 v38, v30, v14
    v_and_b32 v39, v30, v15
    s_nop 1
    v_mfma_f32_16x16x32_bf16 v[16:19], v[64:67], v[36:39], v[16:19]
    v_and_b32 v40, v31, v12
    v_and_b32 v41, v31, v13
    v_and_b32 v42, v31, v14
    v_and_b32 v43, v31, v15
    s_nop 1
    v_mfma_f32_16x16x32_bf16 v[16:19], v[68:71], v[40:43], v[16:19]
    v_and_b32 v36, v32, v12
    v_and_b32 v37, v32, v13
    v_and_b32 v38, v32, v14
    v_and_b32 v39, v32, v15
    s_nop 1
    v_mfma_f32_16x16x32_bf16 v[16:19], v[72:75], v[36:39], v[16:19]
    v_and_b32 v40, v33, v12
    v_and_b32 v41, v33, v13
    v_and_b32 v42, v33, v14
    v_and_b32 v43, v33, v15
    s_nop 1
    v_mfma_f32_16x16x32_bf16 v[16:19], v[76:79], v[40:43], v[16:19]
    v_mov_b32 v44, v21
    s_nop 1
    v_permlane16_swap_b32 v21, v44
    v_add_f32 v21, v21, v44
    v_mov_b32 v44, v21
    s_nop 1
    v_permlane32_swap_b32 v21, v44
    v_add_f32 v21, v21, v44
    v_min_u32 v20, -2, v20
    v_min_u32 v21, -2, v21
    s_mov_b32 exec_lo, 0x03030303
    s_mov_b32 exec_hi, 0x03030303
    buffer_store_dwordx2 v[20:21], v46, s[52:55], s71 offen sc1
    s_mov_b64 exec, -1
    v_min_u32 v16, -2, v16
    v_min_u32 v17, -2, v17
    v_min_u32 v18, -2, v18
    v_min_u32 v19, -2, v19
    buffer_store_dwordx2 v[16:17], v236, s[52:55], s70 offen sc1
    buffer_store_dwordx2 v[18:19], v236, s[52:55], s72 offen sc1
    buffer_load_dwordx4 v[112:115], v45, s[60:63], s3 offen offset:0 nt
    buffer_load_dwordx4 v[116:119], v45, s[60:63], s3 offen offset:1152 nt
    buffer_load_dwordx4 v[120:123], v45, s[60:63], s3 offen offset:2304 nt
    s_add_u32 s3, s3, 3456
    buffer_load_dwordx4 v[124:127], v45, s[60:63], s3 offen offset:0 nt
    buffer_load_dwordx4 v[128:131], v45, s[60:63], s3 offen offset:1152 nt
    buffer_load_dwordx4 v[132:135], v45, s[60:63], s3 offen offset:2304 nt
    s_add_u32 s3, s3, 3456
    buffer_load_dwordx4 v[136:139], v45, s[60:63], s3 offen offset:0 nt
    buffer_load_dwordx4 v[140:143], v45, s[60:63], s3 offen offset:1152 nt
    buffer_load_dwordx4 v[144:147], v45, s[60:63], s3 offen offset:2304 nt
    s_add_u32 s3, s3, 3456
    buffer_load_dwordx4 v[148:151], v45, s[60:63], s3 offen offset:0 nt
    buffer_load_dwordx4 v[152:155], v45, s[60:63], s3 offen offset:1152 nt
    buffer_load_dwordx4 v[156:159], v45, s[60:63], s3 offen offset:2304 nt
    s_add_u32 s3, s3, 3456
    buffer_load_dwordx4 v[160:163], v45, s[60:63], s3 offen offset:0 nt
    buffer_load_dwordx4 v[164:167], v45, s[60:63], s3 offen offset:1152 nt
    buffer_load_dwordx4 v[168:171], v45, s[60:63], s3 offen offset:2304 nt
    s_add_u32 s3, s3, 3456
    buffer_load_dwordx4 v[172:175], v45, s[60:63], s3 offen offset:0 nt
    s_cmp_lt_u32 s68, 2
    s_cbranch_scc1 L_W16
    buffer_load_dwordx4 v[176:179], v45, s[60:63], s3 offen offset:1152 nt
    buffer_load_dwordx4 v[180:183], v45, s[60:63], s3 offen offset:2304 nt
L_W16:
    s_cmp_lt_u32 s68, 2
    s_cbranch_scc1 L_HOP1
    s_waitcnt vmcnt(0)
    v_readlane_b32 s8, v209, 0
    s_nop 0
    s_lshr_b32 s9, s8, 16
    v_dot2_f32_bf16 v88, v112, s9, 0
    v_dot2_f32_bf16 v89, v112, s8, 0
    v_dot2_f32_bf16 v90, v113, s9, 0
    v_dot2_f32_bf16 v91, v113, s8, 0
    v_dot2_f32_bf16 v92, v114, s9, 0
    v_dot2_f32_bf16 v93, v114, s8, 0
    v_dot2_f32_bf16 v94, v115, s9, 0
    v_dot2_f32_bf16 v95, v115, s8, 0
    v_readlane_b32 s10, v209, 1
    s_nop 0
    s_lshr_b32 s11, s10, 16
    v_dot2_f32_bf16 v88, v116, s11, v88
    v_dot2_f32_bf16 v89, v116, s10, v89
    v_dot2_f32_bf16 v90, v117, s11, v90
    v_dot2_f32_bf16 v91, v117, s10, v91
    v_dot2_f32_bf16 v92, v118, s11, v92
    v_dot2_f32_bf16 v93, v118, s10, v93
    v_dot2_f32_bf16 v94, v119, s11, v94
    v_dot2_f32_bf16 v95, v119, s10, v95
    v_readlane_b32 s12, v209, 2
    s_nop 0
    s_lshr_b32 s13, s12, 16
    v_dot2_f32_bf16 v88, v120, s13, v88
    v_dot2_f32_bf16 v89, v120, s12, v89
    v_dot2_f32_bf16 v90, v121, s13, v90
    v_dot2_f32_bf16 v91, v121, s12, v91
    v_dot2_f32_bf16 v92, v122, s13, v92
    v_dot2_f32_bf16 v93, v122, s12, v93
    v_dot2_f32_bf16 v94, v123, s13, v94
    v_dot2_f32_bf16 v95, v123, s12, v95
    v_readlane_b32 s14, v209, 3
    s_nop 0
    s_lshr_b32 s15, s14, 16
    v_dot2_f32_bf16 v88, v124, s15, v88
    v_dot2_f32_bf16 v89, v124, s14, v89
    v_dot2_f32_bf16 v90, v125, s15, v90
    v_dot2_f32_bf16 v91, v125, s14, v91
    v_dot2_f32_bf16 v92, v126, s15, v92
    v_dot2_f32_bf16 v93, v126, s14, v93
    v_dot2_f32_bf16 v94, v127, s15, v94
    v_dot2_f32_bf16 v95, v127, s14, v95
    v_readlane_b32 s8, v209, 4
    s_nop 0
    s_lshr_b32 s9, s8, 16
    v_dot2_f32_bf16 v88, v128, s9, v88
    v_dot2_f32_bf16 v89, v128, s8, v89
    v_dot2_f32_bf16 v90, v129, s9, v90
    v_dot2_f32_bf16 v91, v129, s8, v91
    v_dot2_f32_bf16 v92, v130, s9, v92
    v_dot2_f32_bf16 v93, v130, s8, v93
    v_dot2_f32_bf16 v94, v131, s9, v94
    v_dot2_f32_bf16 v95, v131, s8, v95
    v_readlane_b32 s10, v209, 5
    s_nop 0
    s_lshr_b32 s11, s10, 16
    v_dot2_f32_bf16 v88, v132, s11, v88
    v_dot2_f32_bf16 v89, v132, s10, v89
    v_dot2_f32_bf16 v90, v133, s11, v90
    v_dot2_f32_bf16 v91, v133, s10, v91
    v_dot2_f32_bf16 v92, v134, s11, v92
    v_dot2_f32_bf16 v93, v134, s10, v93
    v_dot2_f32_bf16 v94, v135, s11, v94
    v_dot2_f32_bf16 v95, v135, s10, v95
    v_readlane_b32 s12, v209, 6
    s_nop 0
    s_lshr_b32 s13, s12, 16
    v_dot2_f32_bf16 v88, v136, s13, v88
    v_dot2_f32_bf16 v89, v136, s12, v89
    v_dot2_f32_bf16 v90, v137, s13, v90
    v_dot2_f32_bf16 v91, v137, s12, v91
    v_dot2_f32_bf16 v92, v138, s13, v92
    v_dot2_f32_bf16 v93, v138, s12, v93
    v_dot2_f32_bf16 v94, v139, s13, v94
    v_dot2_f32_bf16 v95, v139, s12, v95
    v_readlane_b32 s14, v209, 7
    s_nop 0
    s_lshr_b32 s15, s14, 16
    v_dot2_f32_bf16 v88, v140, s15, v88
    v_dot2_f32_bf16 v89, v140, s14, v89
    v_dot2_f32_bf16 v90, v141, s15, v90
    v_dot2_f32_bf16 v91, v141, s14, v91
    v_dot2_f32_bf16 v92, v142, s15, v92
    v_dot2_f32_bf16 v93, v142, s14, v93
    v_dot2_f32_bf16 v94, v143, s15, v94
    v_dot2_f32_bf16 v95, v143, s14, v95
    v_readlane_b32 s8, v209, 8
    s_nop 0
    s_lshr_b32 s9, s8, 16
    v_dot2_f32_bf16 v88, v144, s9, v88
    v_dot2_f32_bf16 v89, v144, s8, v89
    v_dot2_f32_bf16 v90, v145, s9, v90
    v_dot2_f32_bf16 v91, v145, s8, v91
    v_dot2_f32_bf16 v92, v146, s9, v92
    v_dot2_f32_bf16 v93, v146, s8, v93
    v_dot2_f32_bf16 v94, v147, s9, v94
    v_dot2_f32_bf16 v95, v147, s8, v95
    v_readlane_b32 s10, v209, 9
    s_nop 0
    s_lshr_b32 s11, s10, 16
    v_dot2_f32_bf16 v88, v148, s11, v88
    v_dot2_f32_bf16 v89, v148, s10, v89
    v_dot2_f32_bf16 v90, v149, s11, v90
    v_dot2_f32_bf16 v91, v149, s10, v91
    v_dot2_f32_bf16 v92, v150, s11, v92
    v_dot2_f32_bf16 v93, v150, s10, v93
    v_dot2_f32_bf16 v94, v151, s11, v94
    v_dot2_f32_bf16 v95, v151, s10, v95
    v_readlane_b32 s12, v209, 10
    s_nop 0
    s_lshr_b32 s13, s12, 16
    v_dot2_f32_bf16 v88, v152, s13, v88
    v_dot2_f32_bf16 v89, v152, s12, v89
    v_dot2_f32_bf16 v90, v153, s13, v90
    v_dot2_f32_bf16 v91, v153, s12, v91
    v_dot2_f32_bf16 v92, v154, s13, v92
    v_dot2_f32_bf16 v93, v154, s12, v93
    v_dot2_f32_bf16 v94, v155, s13, v94
    v_dot2_f32_bf16 v95, v155, s12, v95
    v_readlane_b32 s14, v209, 11
    s_nop 0
    s_lshr_b32 s15, s14, 16
    v_dot2_f32_bf16 v88, v156, s15, v88
    v_dot2_f32_bf16 v89, v156, s14, v89
    v_dot2_f32_bf16 v90, v157, s15, v90
    v_dot2_f32_bf16 v91, v157, s14, v91
    v_dot2_f32_bf16 v92, v158, s15, v92
    v_dot2_f32_bf16 v93, v158, s14, v93
    v_dot2_f32_bf16 v94, v159, s15, v94
    v_dot2_f32_bf16 v95, v159, s14, v95
    v_readlane_b32 s8, v209, 12
    s_nop 0
    s_lshr_b32 s9, s8, 16
    v_dot2_f32_bf16 v88, v160, s9, v88
    v_dot2_f32_bf16 v89, v160, s8, v89
    v_dot2_f32_bf16 v90, v161, s9, v90
    v_dot2_f32_bf16 v91, v161, s8, v91
    v_dot2_f32_bf16 v92, v162, s9, v92
    v_dot2_f32_bf16 v93, v162, s8, v93
    v_dot2_f32_bf16 v94, v163, s9, v94
    v_dot2_f32_bf16 v95, v163, s8, v95
    v_readlane_b32 s10, v209, 13
    s_nop 0
    s_lshr_b32 s11, s10, 16
    v_dot2_f32_bf16 v88, v164, s11, v88
    v_dot2_f32_bf16 v89, v164, s10, v89
    v_dot2_f32_bf16 v90, v165, s11, v90
    v_dot2_f32_bf16 v91, v165, s10, v91
    v_dot2_f32_bf16 v92, v166, s11, v92
    v_dot2_f32_bf16 v93, v166, s10, v93
    v_dot2_f32_bf16 v94, v167, s11, v94
    v_dot2_f32_bf16 v95, v167, s10, v95
    v_readlane_b32 s12, v209, 14
    s_nop 0
    s_lshr_b32 s13, s12, 16
    v_dot2_f32_bf16 v88, v168, s13, v88
    v_dot2_f32_bf16 v89, v168, s12, v89
    v_dot2_f32_bf16 v90, v169, s13, v90
    v_dot2_f32_bf16 v91, v169, s12, v91
    v_dot2_f32_bf16 v92, v170, s13, v92
    v_dot2_f32_bf16 v93, v170, s12, v93
    v_dot2_f32_bf16 v94, v171, s13, v94
    v_dot2_f32_bf16 v95, v171, s12, v95
    v_readlane_b32 s14, v209, 15
    s_nop 0
    s_lshr_b32 s15, s14, 16
    v_dot2_f32_bf16 v88, v172, s15, v88
    v_dot2_f32_bf16 v89, v172, s14, v89
    v_dot2_f32_bf16 v90, v173, s15, v90
    v_dot2_f32_bf16 v91, v173, s14, v91
    v_dot2_f32_bf16 v92, v174, s15, v92
    v_dot2_f32_bf16 v93, v174, s14, v93
    v_dot2_f32_bf16 v94, v175, s15, v94
    v_dot2_f32_bf16 v95, v175, s14, v95
    v_readlane_b32 s8, v209, 16
    s_nop 0
    s_lshr_b32 s9, s8, 16
    v_dot2_f32_bf16 v88, v176, s9, v88
    v_dot2_f32_bf16 v89, v176, s8, v89
    v_dot2_f32_bf16 v90, v177, s9, v90
    v_dot2_f32_bf16 v91, v177, s8, v91
    v_dot2_f32_bf16 v92, v178, s9, v92
    v_dot2_f32_bf16 v93, v178, s8, v93
    v_dot2_f32_bf16 v94, v179, s9, v94
    v_dot2_f32_bf16 v95, v179, s8, v95
    v_readlane_b32 s10, v209, 17
    s_nop 0
    s_lshr_b32 s11, s10, 16
    v_dot2_f32_bf16 v88, v180, s11, v88
    v_dot2_f32_bf16 v89, v180, s10, v89
    v_dot2_f32_bf16 v90, v181, s11, v90
    v_dot2_f32_bf16 v91, v181, s10, v91
    v_dot2_f32_bf16 v92, v182, s11, v92
    v_dot2_f32_bf16 v93, v182, s10, v93
    v_dot2_f32_bf16 v94, v183, s11, v94
    v_dot2_f32_bf16 v95, v183, s10, v95
    v_lshlrev_b32 v35, 13, v238
    s_lshl_b32 s69, s2, 4
    s_add_u32 s69, s69, 0x200000
    s_add_u32 s70, s69, 4096
    v_min_u32 v88, -2, v88
    v_min_u32 v89, -2, v89
    v_min_u32 v90, -2, v90
    v_min_u32 v91, -2, v91
    v_min_u32 v92, -2, v92
    v_min_u32 v93, -2, v93
    v_min_u32 v94, -2, v94
    v_min_u32 v95, -2, v95
    v_cmp_gt_u32 vcc, 72, v238
    s_nop 0
    s_and_saveexec_b64 s[88:89], vcc
    buffer_store_dwordx4 v[88:91], v35, s[52:55], s69 offen sc1
    buffer_store_dwordx4 v[92:95], v35, s[52:55], s70 offen sc1
    s_mov_b64 exec, -1
    s_nop 0
    s_branch L_HOP2
L_HOP1:
    v_lshrrev_b32 v44, 2, v1
    v_lshlrev_b32 v44, 3, v44
    s_lshl_b32 s80, s2, 13
    s_add_u32 s80, s80, 0x400000
    s_add_u32 s69, s80, 4096
    s_mov_b32 s77, 1048576
    buffer_load_dwordx4 v[48:51], v2, s[52:55], s80 offen offset:0 sc1
    buffer_load_dwordx4 v[52:55], v2, s[52:55], s80 offen offset:1024 sc1
    buffer_load_dwordx4 v[56:59], v2, s[52:55], s80 offen offset:2048 sc1
    buffer_load_dwordx4 v[60:63], v2, s[52:55], s80 offen offset:3072 sc1
    buffer_load_dwordx2 v[64:65], v44, s[52:55], s69 offen offset:0 sc1
    buffer_load_dwordx2 v[66:67], v44, s[52:55], s69 offen offset:128 sc1
    buffer_load_dwordx2 v[68:69], v44, s[52:55], s69 offen offset:256 sc1
    buffer_load_dwordx2 v[70:71], v44, s[52:55], s69 offen offset:384 sc1
    s_mov_b32 s3, 0x05040100
    s_mov_b32 s4, 0x07060302
    s_waitcnt vmcnt(8)
    v_perm_b32 v45, v116, v112, s3
    v_perm_b32 v116, v116, v112, s4
    v_mov_b32 v112, v45
    v_perm_b32 v45, v117, v113, s3
    v_perm_b32 v117, v117, v113, s4
    v_mov_b32 v113, v45
    v_perm_b32 v45, v118, v114, s3
    v_perm_b32 v118, v118, v114, s4
    v_mov_b32 v114, v45
    v_perm_b32 v45, v119, v115, s3
    v_perm_b32 v119, v119, v115, s4
    v_mov_b32 v115, v45
    v_perm_b32 v45, v124, v120, s3
    v_perm_b32 v124, v124, v120, s4
    v_mov_b32 v120, v45
    v_perm_b32 v45, v125, v121, s3
    v_perm_b32 v125, v125, v121, s4
    v_mov_b32 v121, v45
    v_perm_b32 v45, v126, v122, s3
    v_perm_b32 v126, v126, v122, s4
    v_mov_b32 v122, v45
    v_perm_b32 v45, v127, v123, s3
    v_perm_b32 v127, v127, v123, s4
    v_mov_b32 v123, v45
    v_perm_b32 v45, v132, v128, s3
    v_perm_b32 v132, v132, v128, s4
    v_mov_b32 v128, v45
    v_perm_b32 v45, v133, v129, s3
    v_perm_b32 v133, v133, v129, s4
    v_mov_b32 v129, v45
    v_perm_b32 v45, v134, v130, s3
    v_perm_b32 v134, v134, v130, s4
    v_mov_b32 v130, v45
    v_perm_b32 v45, v135, v131, s3
    v_perm_b32 v135, v135, v131, s4
    v_mov_b32 v131, v45
    v_perm_b32 v45, v140, v136, s3
    v_perm_b32 v140, v140, v136, s4
    v_mov_b32 v136, v45
    v_perm_b32 v45, v141, v137, s3
    v_perm_b32 v141, v141, v137, s4
    v_mov_b32 v137, v45
    v_perm_b32 v45, v142, v138, s3
    v_perm_b32 v142, v142, v138, s4
    v_mov_b32 v138, v45
    v_perm_b32 v45, v143, v139, s3
    v_perm_b32 v143, v143, v139, s4
    v_mov_b32 v139, v45
    v_perm_b32 v45, v148, v144, s3
    v_perm_b32 v148, v148, v144, s4
    v_mov_b32 v144, v45
    v_perm_b32 v45, v149, v145, s3
    v_perm_b32 v149, v149, v145, s4
    v_mov_b32 v145, v45
    v_perm_b32 v45, v150, v146, s3
    v_perm_b32 v150, v150, v146, s4
    v_mov_b32 v146, v45
    v_perm_b32 v45, v151, v147, s3
    v_perm_b32 v151, v151, v147, s4
    v_mov_b32 v147, v45
    v_perm_b32 v45, v156, v152, s3
    v_perm_b32 v156, v156, v152, s4
    v_mov_b32 v152, v45
    v_perm_b32 v45, v157, v153, s3
    v_perm_b32 v157, v157, v153, s4
    v_mov_b32 v153, v45
    v_perm_b32 v45, v158, v154, s3
    v_perm_b32 v158, v158, v154, s4
    v_mov_b32 v154, v45
    v_perm_b32 v45, v159, v155, s3
    v_perm_b32 v159, v159, v155, s4
    v_mov_b32 v155, v45
    v_perm_b32 v45, v164, v160, s3
    v_perm_b32 v164, v164, v160, s4
    v_mov_b32 v160, v45
    v_perm_b32 v45, v165, v161, s3
    v_perm_b32 v165, v165, v161, s4
    v_mov_b32 v161, v45
    v_perm_b32 v45, v166, v162, s3
    v_perm_b32 v166, v166, v162, s4
    v_mov_b32 v162, v45
    v_perm_b32 v45, v167, v163, s3
    v_perm_b32 v167, v167, v163, s4
    v_mov_b32 v163, v45
    v_perm_b32 v45, v172, v168, s3
    v_perm_b32 v172, v172, v168, s4
    v_mov_b32 v168, v45
    v_perm_b32 v45, v173, v169, s3
    v_perm_b32 v173, v173, v169, s4
    v_mov_b32 v169, v45
    v_perm_b32 v45, v174, v170, s3
    v_perm_b32 v174, v174, v170, s4
    v_mov_b32 v170, v45
    v_perm_b32 v45, v175, v171, s3
    v_perm_b32 v175, v175, v171, s4
    v_mov_b32 v171, v45
    s_nop 4
    s_branch L_H1CHK
L_H1POLL:
    buffer_load_dwordx4 v[48:51], v2, s[52:55], s80 offen offset:0 sc1
    buffer_load_dwordx4 v[52:55], v2, s[52:55], s80 offen offset:1024 sc1
    buffer_load_dwordx4 v[56:59], v2, s[52:55], s80 offen offset:2048 sc1
    buffer_load_dwordx4 v[60:63], v2, s[52:55], s80 offen offset:3072 sc1
    buffer_load_dwordx2 v[64:65], v44, s[52:55], s69 offen offset:0 sc1
    buffer_load_dwordx2 v[66:67], v44, s[52:55], s69 offen offset:128 sc1
    buffer_load_dwordx2 v[68:69], v44, s[52:55], s69 offen offset:256 sc1
    buffer_load_dwordx2 v[70:71], v44, s[52:55], s69 offen offset:384 sc1
L_H1CHK:
    s_waitcnt vmcnt(0)
    v_max3_u32 v45, v48, v49, v50
    v_max3_u32 v46, v51, v52, v53
    v_max3_u32 v45, v45, v54, v55
    v_max3_u32 v46, v46, v56, v57
    v_max3_u32 v45, v45, v58, v59
    v_max3_u32 v46, v46, v60, v61
    v_max3_u32 v45, v45, v62, v63
    v_max3_u32 v46, v46, v64, v65
    v_max3_u32 v45, v45, v66, v67
    v_max3_u32 v46, v46, v68, v69
    v_max3_u32 v45, v45, v70, v71
    v_max_u32 v45, v45, v46
    v_cmp_eq_u32 vcc, -1, v45
    s_sub_u32 s77, s77, 1
    s_cbranch_scc1 L_H1GO
    s_cbranch_vccnz L_H1POLL
L_H1GO:
    v_max3_f32 v45, v64, v66, v68
    v_max_f32 v45, v45, v70
    s_nop 1
    v_max_f32_dpp v45, v45, v45 row_ror:4 row_mask:0xf bank_mask:0xf
    s_nop 1
    v_max_f32_dpp v45, v45, v45 row_ror:8 row_mask:0xf bank_mask:0xf
    v_mov_b32 v46, v45
    s_nop 1
    v_permlane16_swap_b32 v45, v46
    v_max_f32 v45, v45, v46
    v_mov_b32 v46, v45
    s_nop 1
    v_permlane32_swap_b32 v45, v46
    v_max_f32 v45, v45, v46
    v_sub_f32 v64, v64, v45
    v_sub_f32 v66, v66, v45
    v_sub_f32 v68, v68, v45
    v_sub_f32 v70, v70, v45
    v_mul_f32 v64, s75, v64
    v_mul_f32 v66, s75, v66
    v_mul_f32 v68, s75, v68
    v_mul_f32 v70, s75, v70
    v_exp_f32 v64, v64
    v_exp_f32 v66, v66
    v_exp_f32 v68, v68
    v_exp_f32 v70, v70
    v_mul_f32 v72, v64, v65
    v_mul_f32 v48, v48, v64
    v_mul_f32 v49, v49, v64
    v_mul_f32 v50, v50, v64
    v_mul_f32 v51, v51, v64
    v_fmac_f32 v72, v66, v67
    v_fmac_f32 v48, v52, v66
    v_fmac_f32 v49, v53, v66
    v_fmac_f32 v50, v54, v66
    v_fmac_f32 v51, v55, v66
    v_fmac_f32 v72, v68, v69
    v_fmac_f32 v48, v56, v68
    v_fmac_f32 v49, v57, v68
    v_fmac_f32 v50, v58, v68
    v_fmac_f32 v51, v59, v68
    v_fmac_f32 v72, v70, v71
    v_fmac_f32 v48, v60, v70
    v_fmac_f32 v49, v61, v70
    v_fmac_f32 v50, v62, v70
    v_fmac_f32 v51, v63, v70
    v_add_f32_dpp v48, v48, v48 row_ror:4 row_mask:0xf bank_mask:0xf
    v_add_f32_dpp v49, v49, v49 row_ror:4 row_mask:0xf bank_mask:0xf
    v_add_f32_dpp v50, v50, v50 row_ror:4 row_mask:0xf bank_mask:0xf
    v_add_f32_dpp v51, v51, v51 row_ror:4 row_mask:0xf bank_mask:0xf
    v_add_f32_dpp v72, v72, v72 row_ror:4 row_mask:0xf bank_mask:0xf
    v_add_f32_dpp v48, v48, v48 row_ror:8 row_mask:0xf bank_mask:0xf
    v_add_f32_dpp v49, v49, v49 row_ror:8 row_mask:0xf bank_mask:0xf
    v_add_f32_dpp v50, v50, v50 row_ror:8 row_mask:0xf bank_mask:0xf
    v_add_f32_dpp v51, v51, v51 row_ror:8 row_mask:0xf bank_mask:0xf
    v_add_f32_dpp v72, v72, v72 row_ror:8 row_mask:0xf bank_mask:0xf
    v_mov_b32 v36, v48
    v_mov_b32 v37, v49
    v_mov_b32 v38, v50
    v_mov_b32 v39, v51
    v_mov_b32 v40, v72
    v_permlane16_swap_b32 v48, v36
    v_permlane16_swap_b32 v49, v37
    v_permlane16_swap_b32 v50, v38
    v_permlane16_swap_b32 v51, v39
    v_permlane16_swap_b32 v72, v40
    v_add_f32 v48, v48, v36
    v_add_f32 v49, v49, v37
    v_add_f32 v50, v50, v38
    v_add_f32 v51, v51, v39
    v_add_f32 v72, v72, v40
    v_mov_b32 v36, v48
    v_mov_b32 v37, v49
    v_mov_b32 v38, v50
    v_mov_b32 v39, v51
    v_mov_b32 v40, v72
    v_permlane32_swap_b32 v48, v36
    v_permlane32_swap_b32 v49, v37
    v_permlane32_swap_b32 v50, v38
    v_permlane32_swap_b32 v51, v39
    v_permlane32_swap_b32 v72, v40
    v_add_f32 v48, v48, v36
    v_add_f32 v49, v49, v37
    v_add_f32 v50, v50, v38
    v_add_f32 v51, v51, v39
    v_add_f32 v72, v72, v40
    v_rcp_f32 v45, v72
    s_nop 0
    v_mul_f32 v36, v48, v45
    v_fma_f32 v48, -v36, v72, v48
    v_fmac_f32 v36, v48, v45
    v_mul_f32 v37, v49, v45
    v_fma_f32 v49, -v37, v72, v49
    v_fmac_f32 v37, v49, v45
    v_mul_f32 v38, v50, v45
    v_fma_f32 v50, -v38, v72, v50
    v_fmac_f32 v38, v50, v45
    v_mul_f32 v39, v51, v45
    v_fma_f32 v51, -v39, v72, v51
    v_fmac_f32 v39, v51, v45
    v_cvt_pk_bf16_f32 v40, v36, v38
    v_cvt_pk_bf16_f32 v41, v37, v39
    v_readlane_b32 s8, v40, 0
    v_readlane_b32 s12, v41, 0
    v_readlane_b32 s9, v40, 1
    v_readlane_b32 s13, v41, 1
    v_readlane_b32 s10, v40, 2
    v_readlane_b32 s14, v41, 2
    v_readlane_b32 s11, v40, 3
    v_readlane_b32 s15, v41, 3
    v_dot2_f32_bf16 v88, v112, s8, 0
    v_dot2_f32_bf16 v89, v116, s8, 0
    v_dot2_f32_bf16 v90, v113, s8, 0
    v_dot2_f32_bf16 v91, v117, s8, 0
    v_dot2_f32_bf16 v92, v114, s8, 0
    v_dot2_f32_bf16 v93, v118, s8, 0
    v_dot2_f32_bf16 v94, v115, s8, 0
    v_dot2_f32_bf16 v95, v119, s8, 0
    v_dot2_f32_bf16 v88, v120, s9, v88
    v_dot2_f32_bf16 v89, v124, s9, v89
    v_dot2_f32_bf16 v90, v121, s9, v90
    v_dot2_f32_bf16 v91, v125, s9, v91
    v_dot2_f32_bf16 v92, v122, s9, v92
    v_dot2_f32_bf16 v93, v126, s9, v93
    v_dot2_f32_bf16 v94, v123, s9, v94
    v_dot2_f32_bf16 v95, v127, s9, v95
    v_dot2_f32_bf16 v88, v128, s10, v88
    v_dot2_f32_bf16 v89, v132, s10, v89
    v_dot2_f32_bf16 v90, v129, s10, v90
    v_dot2_f32_bf16 v91, v133, s10, v91
    v_dot2_f32_bf16 v92, v130, s10, v92
    v_dot2_f32_bf16 v93, v134, s10, v93
    v_dot2_f32_bf16 v94, v131, s10, v94
    v_dot2_f32_bf16 v95, v135, s10, v95
    v_dot2_f32_bf16 v88, v136, s11, v88
    v_dot2_f32_bf16 v89, v140, s11, v89
    v_dot2_f32_bf16 v90, v137, s11, v90
    v_dot2_f32_bf16 v91, v141, s11, v91
    v_dot2_f32_bf16 v92, v138, s11, v92
    v_dot2_f32_bf16 v93, v142, s11, v93
    v_dot2_f32_bf16 v94, v139, s11, v94
    v_dot2_f32_bf16 v95, v143, s11, v95
    v_dot2_f32_bf16 v88, v144, s12, v88
    v_dot2_f32_bf16 v89, v148, s12, v89
    v_dot2_f32_bf16 v90, v145, s12, v90
    v_dot2_f32_bf16 v91, v149, s12, v91
    v_dot2_f32_bf16 v92, v146, s12, v92
    v_dot2_f32_bf16 v93, v150, s12, v93
    v_dot2_f32_bf16 v94, v147, s12, v94
    v_dot2_f32_bf16 v95, v151, s12, v95
    v_dot2_f32_bf16 v88, v152, s13, v88
    v_dot2_f32_bf16 v89, v156, s13, v89
    v_dot2_f32_bf16 v90, v153, s13, v90
    v_dot2_f32_bf16 v91, v157, s13, v91
    v_dot2_f32_bf16 v92, v154, s13, v92
    v_dot2_f32_bf16 v93, v158, s13, v93
    v_dot2_f32_bf16 v94, v155, s13, v94
    v_dot2_f32_bf16 v95, v159, s13, v95
    v_dot2_f32_bf16 v88, v160, s14, v88
    v_dot2_f32_bf16 v89, v164, s14, v89
    v_dot2_f32_bf16 v90, v161, s14, v90
    v_dot2_f32_bf16 v91, v165, s14, v91
    v_dot2_f32_bf16 v92, v162, s14, v92
    v_dot2_f32_bf16 v93, v166, s14, v93
    v_dot2_f32_bf16 v94, v163, s14, v94
    v_dot2_f32_bf16 v95, v167, s14, v95
    v_dot2_f32_bf16 v88, v168, s15, v88
    v_dot2_f32_bf16 v89, v172, s15, v89
    v_dot2_f32_bf16 v90, v169, s15, v90
    v_dot2_f32_bf16 v91, v173, s15, v91
    v_dot2_f32_bf16 v92, v170, s15, v92
    v_dot2_f32_bf16 v93, v174, s15, v93
    v_dot2_f32_bf16 v94, v171, s15, v94
    v_dot2_f32_bf16 v95, v175, s15, v95
    v_lshlrev_b32 v35, 13, v0
    s_lshl_b32 s69, s2, 4
    s_add_u32 s69, s69, 0x100000
    s_add_u32 s70, s69, 4096
    v_min_u32 v88, -2, v88
    v_min_u32 v89, -2, v89
    v_min_u32 v90, -2, v90
    v_min_u32 v91, -2, v91
    v_min_u32 v92, -2, v92
    v_min_u32 v93, -2, v93
    v_min_u32 v94, -2, v94
    v_min_u32 v95, -2, v95
    v_cmp_gt_u32 vcc, 72, v0
    s_nop 0
    s_and_saveexec_b64 s[88:89], vcc
    buffer_store_dwordx4 v[88:91], v35, s[52:55], s69 offen sc1
    buffer_store_dwordx4 v[92:95], v35, s[52:55], s70 offen sc1
    s_mov_b64 exec, -1
    s_nop 0
L_HOP2:
    s_cmp_ge_u32 s2, 144
    s_cbranch_scc1 L_END
    v_lshlrev_b32 v35, 4, v0
    s_lshl_b32 s69, s2, 12
    s_add_u32 s69, s69, 0x100000
    s_add_u32 s70, s69, 0x100000
    s_lshl_b32 s71, s2, 3
    v_lshlrev_b32 v236, 1, v1
    buffer_load_ushort v238, v236, s[40:43], s71 offen
    s_mov_b32 s77, 1048576
    s_nop 2
L_H2POLL:
    buffer_load_dwordx4 v[48:51], v35, s[52:55], s69 offen sc1
    buffer_load_dwordx4 v[52:55], v35, s[52:55], s70 offen sc1
    s_waitcnt vmcnt(0)
    v_max3_u32 v45, v48, v49, v50
    v_max3_u32 v46, v51, v52, v53
    v_max3_u32 v45, v45, v54, v55
    v_max_u32 v45, v45, v46
    v_cmp_eq_u32 vcc, -1, v45
    s_sub_u32 s77, s77, 1
    s_cbranch_scc1 L_H2GO
    s_cbranch_vccnz L_H2POLL
L_H2GO:
    v_permlane32_swap_b32 v48, v52
    v_permlane32_swap_b32 v49, v53
    v_permlane32_swap_b32 v50, v54
    v_permlane32_swap_b32 v51, v55
    v_add_f32 v48, v48, v52
    v_add_f32 v49, v49, v53
    v_add_f32 v50, v50, v54
    v_add_f32 v51, v51, v55
    v_permlane16_swap_b32 v48, v49
    s_nop 0
    v_permlane16_swap_b32 v50, v51
    v_add_f32 v52, v48, v49
    v_add_f32 v53, v50, v51
    s_nop 0
    v_add_f32_dpp v52, v52, v52 row_ror:8 row_mask:0xf bank_mask:0xf
    v_add_f32_dpp v53, v53, v53 row_ror:8 row_mask:0xf bank_mask:0xf
    s_nop 0
    v_add_f32_dpp v52, v52, v52 row_ror:4 row_mask:0xf bank_mask:0xf
    v_add_f32_dpp v53, v53, v53 row_ror:4 row_mask:0xf bank_mask:0xf
    s_nop 0
    v_add_f32_dpp v52, v52, v52 row_ror:2 row_mask:0xf bank_mask:0xf
    v_add_f32_dpp v53, v53, v53 row_ror:2 row_mask:0xf bank_mask:0xf
    s_nop 0
    v_add_f32_dpp v52, v52, v52 row_ror:1 row_mask:0xf bank_mask:0xf
    v_add_f32_dpp v53, v53, v53 row_ror:1 row_mask:0xf bank_mask:0xf
    v_lshrrev_b32 v35, 1, v1
    s_lshl_b32 s69, s68, 5
    v_add_u32 v35, s69, v35
    s_mov_b32 exec_lo, 0x00010001
    s_mov_b32 exec_hi, 0x00010001
    ds_write_b64 v35, v[52:53] offset:9856
    s_mov_b64 exec, -1
    s_waitcnt lgkmcnt(0)
    s_barrier
    s_cmp_lg_u32 s68, 0
    s_cbranch_scc1 L_END
    v_and_b32 v35, 1, v1
    v_lshlrev_b32 v35, 3, v35
    v_and_b32 v44, 2, v1
    v_lshl_add_u32 v35, v44, 1, v35
    ds_read_b32 v48, v35 offset:9856
    ds_read_b32 v52, v35 offset:9872
    ds_read_b32 v49, v35 offset:9888
    ds_read_b32 v53, v35 offset:9904
    ds_read_b32 v50, v35 offset:9920
    ds_read_b32 v54, v35 offset:9936
    ds_read_b32 v51, v35 offset:9952
    ds_read_b32 v55, v35 offset:9968
    s_waitcnt lgkmcnt(0)
    v_add_f32 v48, v48, v49
    v_add_f32 v50, v50, v51
    v_add_f32 v48, v48, v50
    v_cvt_pk_bf16_f32 v48, v48, v48
    v_and_b32 v48, 0xffff0000, v48
    v_add_f32 v52, v52, v53
    v_add_f32 v54, v54, v55
    v_add_f32 v52, v52, v54
    v_cvt_pk_bf16_f32 v52, v52, v52
    v_and_b32 v52, 0xffff0000, v52
    v_mul_f32 v35, s75, v52
    v_exp_f32 v35, -v35
    s_nop 0
    v_add_f32 v35, 1.0, v35
    v_rcp_f32 v35, v35
    s_nop 0
    v_mul_f32 v35, v35, v52
    v_cvt_pk_bf16_f32 v35, v35, v35
    v_and_b32 v35, 0xffff0000, v35
    v_mul_f32 v35, v35, v48
    v_cvt_pk_bf16_f32 v35, v35, v35
    v_and_b32 v35, 0xffff0000, v35
    v_lshlrev_b32 v238, 16, v238
    v_add_f32 v35, v35, v238
    v_cvt_pk_bf16_f32 v35, v35, v35
    s_mov_b64 exec, 15
    buffer_store_short v35, v236, s[56:59], s71 offen
    s_mov_b64 exec, -1
L_END:
    s_endpgm
.section .rodata,"a"
.p2align 6
.amdhsa_kernel recurrent_scan__gqa_block_cached__swiglu_ffn__decode_kernel
  .amdhsa_next_free_vgpr 244
  .amdhsa_next_free_sgpr 102
  .amdhsa_accum_offset 244
  .amdhsa_group_segment_fixed_size 0
  .amdhsa_kernarg_size 96
  .amdhsa_user_sgpr_count 2
  .amdhsa_user_sgpr_kernarg_segment_ptr 1
  .amdhsa_system_sgpr_workgroup_id_x 1
  .amdhsa_float_denorm_mode_32 3
.end_amdhsa_kernel
```
